```python
import torch

def _softmax(x, axis=-1):
    return torch.softmax(x, dim=axis)
def _gelu(x):
    return torch.nn.functional.gelu(x, approximate="tanh")
def _silu(x):
    return torch.nn.functional.silu(x)
def _sigmoid(x):
    return torch.sigmoid(x)
def _layernorm(x, axis=-1, eps=1e-5):
    m = x.mean(dim=axis, keepdim=True)
    v = x.var(dim=axis, keepdim=True, unbiased=False)
    return (x - m) / torch.sqrt(v + eps)
def _scatter_add(tgt, idx, src, axis=0):
    return tgt.clone().index_add_(axis, idx, src)
def _segment_sum(src, seg, n):
    out = torch.zeros((n,) + src.shape[1:], dtype=src.dtype)
    return out.index_add_(0, seg, src)
def _pad(x, pw):
    flat = tuple(v for pair in reversed(pw) for v in pair)
    return torch.nn.functional.pad(x, flat)

kernel_name = 'recurrent_scan__linear_attn_block__dense_activation_relu__prompt'

def setup_inputs():

    _w = (lambda a: (lambda t: t.to(torch.bfloat16) if t.is_floating_point() else t)(torch.as_tensor(a)))
    def _A_setup():
        B, S, D = 1, 2048, 512
        return {
            "x": _w((lambda *s: torch.randn(*s, dtype=torch.bfloat16) * 0.05)(B, S, D)),
            "wqkv": _w((lambda *s: torch.randn(*s, dtype=torch.bfloat16) * 0.05)(D, 3 * D)),
            "wo": _w((lambda *s: torch.randn(*s, dtype=torch.bfloat16) * 0.05)(D, D)),
        }
    _A_in = _A_setup()

    def _B_setup():
        B, S, D, Dff = 1, 2048, 512, 1792
        return {
            "x": _w((lambda *s: torch.randn(*s, dtype=torch.bfloat16) * 0.05)(B, S, D)),
            "w1": _w((lambda *s: torch.randn(*s, dtype=torch.bfloat16) * 0.05)(D, Dff)),
            "w2": _w((lambda *s: torch.randn(*s, dtype=torch.bfloat16) * 0.05)(Dff, D)),
        }
    _B_in = _B_setup()

    return {
        "A_x": _A_in["x"],
        "A_wqkv": _A_in["wqkv"],
        "A_wo": _A_in["wo"],
        "B_x": _B_in["x"],
        "B_w1": _B_in["w1"],
        "B_w2": _B_in["w2"],
    }

def reference(A_x, A_wqkv, A_wo, B_x, B_w1, B_w2):
    def _A_ref(x, wqkv, wo):
        B, S, D = x.shape
        H = 32; Dh = D // H
        qkv = (lambda x, *d: x.permute(*d))((x @ wqkv).reshape(B, S, 3, H, Dh), 2, 0, 3, 1, 4)
        q, k, v = qkv[0], qkv[1], qkv[2]
        phi = lambda t: torch.where(t > 0, t + 1, torch.exp(t)) + 1e-6
        pq, pk = phi(q), phi(k)
        kv = torch.einsum("bhsd,bhse->bhde", pk, v)
        z = torch.einsum("bhsd->bhd", pk)
        num = torch.einsum("bhqd,bhde->bhqe", pq, kv)
        den = torch.einsum("bhqd,bhd->bhq", pq, z)[..., None] + 1e-6
        o = num / den
        return (lambda x, *d: x.permute(*d))(o, 0, 2, 1, 3).reshape(B, S, D) @ wo

    def _B_ref(x, w1, w2):
        h = torch.einsum("bsd,df->bsf", x, w1)
        zero = torch.zeros_like(h)
        h = torch.maximum(h, zero)
        return torch.einsum("bsf,fd->bsd", h, w2)

    x = A_x
    xn = _layernorm(x, axis=-1)
    s = _A_ref(xn, A_wqkv, A_wo)
    g = _silu(_B_ref(xn, B_w1, B_w2))
    return x + s * g
```

```asm
; @launch grid=(256,1,1) block=(256,1,1) lds=163840
.amdgcn_target "amdgcn-amd-amdhsa--gfx950"
.text
.globl recurrent_scan__linear_attn_block__dense_activation_relu__prompt_kernel
.p2align 8
.type recurrent_scan__linear_attn_block__dense_activation_relu__prompt_kernel,@function
recurrent_scan__linear_attn_block__dense_activation_relu__prompt_kernel:
    s_cmp_ge_u32 s2, 256
    s_cbranch_scc1 L_end
    s_load_dwordx16 s[72:87], s[0:1], 0
    s_load_dwordx2 s[88:89], s[0:1], 64
    v_and_b32 v1, 63, v0
    v_lshrrev_b32 v2, 6, v0
    s_nop 0
    v_readfirstlane_b32 s36, v2
    s_and_b32 s56, s2, 7
    s_lshr_b32 s57, s2, 3
    s_and_b32 s58, s56, 1
    s_lshl_b32 s58, s58, 3
    s_and_b32 s59, s57, 7
    s_add_u32 s37, s58, s59
    s_lshr_b32 s58, s56, 1
    s_lshl_b32 s58, s58, 2
    s_lshr_b32 s60, s57, 3
    s_add_u32 s61, s58, s60
    s_lshr_b32 s38, s61, 1
    s_lshl_b32 s60, s60, 1
    s_add_u32 s59, s59, s60
    s_and_b32 s39, s59, 7
    s_lshl_b32 s58, s56, 2
    s_and_b32 s59, s57, 3
    s_add_u32 s64, s58, s59
    s_lshr_b32 s65, s57, 2
    s_lshl_b32 s43, s36, 10
    s_lshl_b32 s46, s36, 12
    s_add_u32 s46, s46, 65536
    s_lshl_b32 s58, s37, 7
    s_lshl_b32 s59, s36, 5
    s_add_u32 s58, s58, s59
    v_lshrrev_b32 v2, 2, v1
    v_add_u32 v3, s58, v2
    v_lshrrev_b32 v4, 4, v1
    v_xor_b32 v4, v4, v1
    v_and_b32 v4, 3, v4
    v_lshlrev_b32 v4, 4, v4
    v_lshl_add_u32 v228, v3, 10, v4
    v_add_u32 v229, 64, v228
    v_add_u32 v230, 16384, v228
    v_add_u32 v231, 16448, v228
    s_lshl_b32 s59, s36, 4
    v_add_u32 v5, s59, v2
    v_and_b32 v6, 3, v1
    v_lshlrev_b32 v6, 4, v6
    s_movk_i32 s62, 3072
    s_movk_i32 s63, 3584
    v_mad_u32_u24 v7, v5, s62, v6
    v_mad_u32_u24 v8, v5, s63, v6
    s_lshl_b32 s40, s39, 7
    s_mul_i32 s41, s39, 196608
    s_mul_i32 s42, s39, 229376
    s_lshl_b32 s39, s39, 29
    s_and_b32 s61, s61, 1
    s_waitcnt lgkmcnt(0)
    s_mov_b32 s4, s72
    s_mov_b32 s5, s73
    s_mov_b32 s6, 2097152
    s_mov_b32 s7, 0x00020000
    s_mov_b32 s8, s74
    s_mov_b32 s9, s75
    s_mov_b32 s10, 1572864
    s_mov_b32 s11, 0x00020000
    s_mov_b32 s12, s80
    s_mov_b32 s13, s81
    s_mov_b32 s14, 1835008
    s_mov_b32 s15, 0x00020000
    s_mov_b32 s32, s86
    s_mov_b32 s33, s87
    s_mov_b32 s34, 256
    s_mov_b32 s35, 0x00020000
    s_cmp_lg_u32 s2, 0
    s_cbranch_scc1 nn_1
    s_cmp_lg_u32 s36, 0
    s_cbranch_scc1 nn_1
    s_memrealtime s[56:57]
    s_waitcnt lgkmcnt(0)
    s_or_b32 s56, s56, 1
    v_mov_b32 v10, s56
    v_mov_b32 v11, s57
    v_mov_b32 v12, 0
    s_mov_b64 exec, 1
    buffer_store_dwordx2 v[10:11], v12, s[32:35], 0 offen sc1
    s_mov_b64 exec, -1
nn_1:
    s_cmp_eq_u32 s61, 1
    s_cbranch_scc1 L_typeB
    s_lshr_b32 s57, s38, 1
    s_mul_i32 s57, s57, 896
    s_and_b32 s58, s38, 1
    s_lshl_b32 s59, s58, 7
    s_add_u32 s90, s57, s59
    s_lshl_b32 s56, s38, 7
    s_add_u32 s57, s56, 1024
    v_add_u32 v220, s57, v7
    s_add_u32 s57, s56, 1088
    v_add_u32 v221, s57, v7
    s_add_u32 s57, s56, 2048
    v_add_u32 v222, s57, v7
    s_add_u32 s57, s56, 2112
    v_add_u32 v223, s57, v7
    s_add_u32 s90, s90, 640
    v_add_u32 v224, s90, v8
    v_add_u32 v225, 64, v224
    s_add_u32 m0, s46, 0
    s_nop 0
    buffer_load_dwordx4 v228, s[4:7], s40 offen lds
    s_add_u32 m0, s46, 1024
    s_nop 0
    buffer_load_dwordx4 v229, s[4:7], s40 offen lds
    s_add_u32 m0, s46, 2048
    s_nop 0
    buffer_load_dwordx4 v230, s[4:7], s40 offen lds
    s_add_u32 m0, s46, 3072
    s_nop 0
    buffer_load_dwordx4 v231, s[4:7], s40 offen lds
    s_add_u32 m0, s43, 0
    s_nop 0
    buffer_load_dwordx4 v220, s[8:11], s41 offen lds
    s_add_u32 m0, s43, 4096
    s_nop 0
    buffer_load_dwordx4 v221, s[8:11], s41 offen lds
    s_add_u32 m0, s43, 8192
    s_nop 0
    buffer_load_dwordx4 v222, s[8:11], s41 offen lds
    s_add_u32 m0, s43, 12288
    s_nop 0
    buffer_load_dwordx4 v223, s[8:11], s41 offen lds
    s_add_u32 s39, s39, 0x20000000
    s_lshr_b32 s40, s39, 22
    s_mul_hi_u32 s41, s39, 1572864
    s_add_u32 m0, s46, 16384
    s_nop 0
    buffer_load_dwordx4 v228, s[4:7], s40 offen lds
    s_add_u32 m0, s46, 17408
    s_nop 0
    buffer_load_dwordx4 v229, s[4:7], s40 offen lds
    s_add_u32 m0, s46, 18432
    s_nop 0
    buffer_load_dwordx4 v230, s[4:7], s40 offen lds
    s_add_u32 m0, s46, 19456
    s_nop 0
    buffer_load_dwordx4 v231, s[4:7], s40 offen lds
    s_add_u32 m0, s43, 16384
    s_nop 0
    buffer_load_dwordx4 v220, s[8:11], s41 offen lds
    s_add_u32 m0, s43, 20480
    s_nop 0
    buffer_load_dwordx4 v221, s[8:11], s41 offen lds
    s_add_u32 m0, s43, 24576
    s_nop 0
    buffer_load_dwordx4 v222, s[8:11], s41 offen lds
    s_add_u32 m0, s43, 28672
    s_nop 0
    buffer_load_dwordx4 v223, s[8:11], s41 offen lds
    s_add_u32 s39, s39, 0x20000000
    s_lshr_b32 s40, s39, 22
    s_mul_hi_u32 s41, s39, 1572864
    s_add_u32 m0, s46, 32768
    s_nop 0
    buffer_load_dwordx4 v228, s[4:7], s40 offen lds
    s_add_u32 m0, s46, 33792
    s_nop 0
    buffer_load_dwordx4 v229, s[4:7], s40 offen lds
    s_add_u32 m0, s46, 34816
    s_nop 0
    buffer_load_dwordx4 v230, s[4:7], s40 offen lds
    s_add_u32 m0, s46, 35840
    s_nop 0
    buffer_load_dwordx4 v231, s[4:7], s40 offen lds
    s_add_u32 m0, s43, 32768
    s_nop 0
    buffer_load_dwordx4 v220, s[8:11], s41 offen lds
    s_add_u32 m0, s43, 36864
    s_nop 0
    buffer_load_dwordx4 v221, s[8:11], s41 offen lds
    s_add_u32 m0, s43, 40960
    s_nop 0
    buffer_load_dwordx4 v222, s[8:11], s41 offen lds
    s_add_u32 m0, s43, 45056
    s_nop 0
    buffer_load_dwordx4 v223, s[8:11], s41 offen lds
    s_mov_b32 s20, s76
    s_mov_b32 s21, s77
    s_mov_b32 s22, 524288
    s_mov_b32 s23, 0x00020000
    s_mov_b32 s16, s82
    s_mov_b32 s17, s83
    s_mov_b32 s18, 1835008
    s_mov_b32 s19, 0x00020000
    s_mov_b32 s24, s84
    s_mov_b32 s25, s85
    s_mov_b32 s26, 2097152
    s_mov_b32 s27, 0x00020000
    s_mov_b32 s28, s88
    s_mov_b32 s29, s89
    s_mov_b32 s30, 16777216
    s_mov_b32 s31, 0x00020000
    v_lshrrev_b32 v9, 5, v1
    v_lshlrev_b32 v10, 9, v9
    v_bfe_u32 v11, v1, 2, 2
    v_lshl_add_u32 v10, v11, 6, v10
    v_bfe_u32 v11, v1, 4, 1
    v_lshl_add_u32 v10, v11, 5, v10
    v_and_b32 v11, 3, v1
    v_lshl_add_u32 v10, v11, 3, v10
    v_bfe_u32 v11, v1, 4, 1
    v_lshlrev_b32 v11, 11, v11
    v_and_b32 v12, 15, v1
    v_lshl_add_u32 v11, v12, 6, v11
    v_add_u32 v11, s46, v11
    v_bfe_u32 v12, v1, 2, 2
    s_add_u32 s56, s36, 0
    s_and_b32 s56, s56, 3
    s_lshl_b32 s57, s56, 10
    v_add_u32 v212, s57, v10
    s_and_b32 s57, s56, 1
    s_lshl_b32 s57, s57, 1
    s_lshr_b32 s58, s56, 1
    s_lshl_b32 s58, s58, 10
    v_add_u32 v13, s57, v9
    v_xor_b32 v13, v13, v12
    v_lshl_add_u32 v13, v13, 4, v11
    v_add_u32 v216, s58, v13
    s_add_u32 s56, s36, 1
    s_and_b32 s56, s56, 3
    s_lshl_b32 s57, s56, 10
    v_add_u32 v213, s57, v10
    s_and_b32 s57, s56, 1
    s_lshl_b32 s57, s57, 1
    s_lshr_b32 s58, s56, 1
    s_lshl_b32 s58, s58, 10
    v_add_u32 v13, s57, v9
    v_xor_b32 v13, v13, v12
    v_lshl_add_u32 v13, v13, 4, v11
    v_add_u32 v217, s58, v13
    s_add_u32 s56, s36, 2
    s_and_b32 s56, s56, 3
    s_lshl_b32 s57, s56, 10
    v_add_u32 v214, s57, v10
    s_and_b32 s57, s56, 1
    s_lshl_b32 s57, s57, 1
    s_lshr_b32 s58, s56, 1
    s_lshl_b32 s58, s58, 10
    v_add_u32 v13, s57, v9
    v_xor_b32 v13, v13, v12
    v_lshl_add_u32 v13, v13, 4, v11
    v_add_u32 v218, s58, v13
    s_add_u32 s56, s36, 3
    s_and_b32 s56, s56, 3
    s_lshl_b32 s57, s56, 10
    v_add_u32 v215, s57, v10
    s_and_b32 s57, s56, 1
    s_lshl_b32 s57, s57, 1
    s_lshr_b32 s58, s56, 1
    s_lshl_b32 s58, s58, 10
    v_add_u32 v13, s57, v9
    v_xor_b32 v13, v13, v12
    v_lshl_add_u32 v13, v13, 4, v11
    v_add_u32 v219, s58, v13
    s_mov_b32 s56, 0x3f803f80
    v_mov_b32 v208, s56
    v_mov_b32 v209, s56
    v_mov_b32 v210, s56
    v_mov_b32 v211, s56
    v_bfe_u32 v11, v1, 4, 1
    v_lshlrev_b32 v11, 2, v11
    v_and_b32 v12, 7, v1
    v_cmp_eq_u32 vcc, v11, v12
    v_cndmask_b32 v204, 0, v208, vcc
    v_mov_b32 v205, v204
    v_mov_b32 v206, v204
    v_mov_b32 v207, v204
    s_mov_b32 s54, 0xffff
    s_mov_b32 s55, 0xffff
    s_mov_b32 s100, -1
    s_mov_b32 s101, 0
    s_mov_b32 s66, 0x358637bd
    s_mov_b32 s68, 0x3f317218
    s_mov_b32 s69, 0xffff0000
    s_lshl_b32 s56, s37, 2
    s_add_u32 s56, s56, s36
    s_mul_i32 s57, s56, 114688
    s_lshl_b32 s58, s56, 15
    s_add_u32 s58, s58, 8388608
    v_lshlrev_b32 v11, 4, v1
    v_add_u32 v4, s57, v11
    v_add_u32 v5, s58, v11
    v_and_b32 v6, 31, v1
    v_lshlrev_b32 v6, 4, v6
    v_add_u32 v6, 153600, v6
    s_lshl_b32 s56, s36, 2
    v_add_u32 v3, s56, v6
    v_mov_b32 v243, 0
    s_lshl_b32 s51, s90, 5
    s_add_u32 s52, s51, 2048
    s_waitcnt vmcnt(16)
    s_barrier
    ds_read_b64_tr_b16 v[128:129], v212 offset:0
    ds_read_b64_tr_b16 v[130:131], v212 offset:256
    ds_read_b128 a[0:3], v216 offset:0
    ds_read_b64_tr_b16 v[132:133], v212 offset:4096
    ds_read_b64_tr_b16 v[134:135], v212 offset:4352
    ds_read_b64_tr_b16 v[136:137], v212 offset:8192
    ds_read_b64_tr_b16 v[138:139], v212 offset:8448
    ds_read_b64_tr_b16 v[140:141], v212 offset:12288
    ds_read_b64_tr_b16 v[142:143], v212 offset:12544
    s_waitcnt lgkmcnt(4)
    v_mfma_f32_32x32x16_bf16 v[16:31], a[0:3], v[128:131], 0
    ds_read_b64_tr_b16 v[144:145], v213 offset:0
    ds_read_b64_tr_b16 v[146:147], v213 offset:256
    ds_read_b128 a[4:7], v217 offset:0
    v_mfma_f32_16x16x32_bf16 v[176:179], v[204:207], v[128:131], 0
    s_lshl_b32 s56, s2, 2
    s_add_u32 s56, s56, s36
    v_lshrrev_b32 v244, 2, v1
    v_and_b32 v245, 3, v1
    v_mfma_f32_32x32x16_bf16 v[32:47], a[0:3], v[132:135], 0
    ds_read_b64_tr_b16 v[148:149], v213 offset:4096
    ds_read_b64_tr_b16 v[150:151], v213 offset:4352
    v_mfma_f32_16x16x32_bf16 v[180:183], v[204:207], v[132:135], 0
    s_mul_i32 s57, s56, 1792
    v_lshlrev_b32 v245, 4, v245
    v_lshl_add_u32 v244, v244, 10, v245
    s_waitcnt lgkmcnt(5)
    v_mfma_f32_32x32x16_bf16 v[48:63], a[0:3], v[136:139], 0
    ds_read_b64_tr_b16 v[152:153], v213 offset:8192
    ds_read_b64_tr_b16 v[154:155], v213 offset:8448
    v_mfma_f32_16x16x32_bf16 v[184:187], v[204:207], v[136:139], 0
    v_min_u32 v248, 13, v1
    s_lshl_b32 s58, s65, 7
    s_and_b32 s59, s36, 1
    v_mfma_f32_32x32x16_bf16 v[64:79], a[0:3], v[140:143], 0
    ds_read_b64_tr_b16 v[156:157], v213 offset:12288
    ds_read_b64_tr_b16 v[158:159], v213 offset:12544
    v_mfma_f32_16x16x32_bf16 v[188:191], v[204:207], v[140:143], 0
    v_lshlrev_b32 v248, 7, v248
    s_lshl_b32 s59, s59, 6
    s_add_u32 s60, s58, s59
    v_mfma_f32_4x4x4_16b_bf16 v[160:163], a[0:1], v[208:209], 0
    s_xor_b32 s59, s59, 64
    v_mfma_f32_4x4x4_16b_bf16 v[164:167], a[0:1], a[0:1], 0
    s_add_u32 s59, s58, s59
    v_mfma_f32_4x4x4_16b_bf16 v[168:171], a[2:3], v[208:209], 0
    v_add_u32 v254, s60, v244
    v_mfma_f32_4x4x4_16b_bf16 v[172:175], a[2:3], a[2:3], 0
    v_add_u32 v255, s59, v244
    s_waitcnt lgkmcnt(4)
    v_mfma_f32_32x32x16_bf16 v[16:31], a[4:7], v[144:147], v[16:31]
    ds_read_b64_tr_b16 v[128:129], v214 offset:0
    ds_read_b64_tr_b16 v[130:131], v214 offset:256
    ds_read_b128 a[8:11], v218 offset:0
    buffer_load_dword v249, v248, s[16:19], s57 offen
    s_mul_i32 s3, s36, 12288
    v_mfma_f32_32x32x16_bf16 v[32:47], a[4:7], v[148:151], v[32:47]
    ds_read_b64_tr_b16 v[132:133], v214 offset:4096
    ds_read_b64_tr_b16 v[134:135], v214 offset:4352
    s_lshl_b32 s57, s56, 9
    s_add_u32 s3, s3, 98304
    s_waitcnt lgkmcnt(5)
    v_mfma_f32_32x32x16_bf16 v[48:63], a[4:7], v[152:155], v[48:63]
    ds_read_b64_tr_b16 v[136:137], v214 offset:8192
    ds_read_b64_tr_b16 v[138:139], v214 offset:8448
    v_and_b32 v248, 0x180, v248
    v_lshrrev_b32 v244, 5, v1
    v_mfma_f32_32x32x16_bf16 v[64:79], a[4:7], v[156:159], v[64:79]
    ds_read_b64_tr_b16 v[140:141], v214 offset:12288
    ds_read_b64_tr_b16 v[142:143], v214 offset:12544
    buffer_load_dword v250, v248, s[20:23], s57 offen
    v_lshlrev_b32 v244, 8, v244
    v_mfma_f32_4x4x4_16b_bf16 v[160:163], a[4:5], v[208:209], v[160:163]
    v_bfe_u32 v245, v1, 2, 2
    v_mfma_f32_4x4x4_16b_bf16 v[164:167], a[4:5], a[4:5], v[164:167]
    v_lshl_add_u32 v244, v245, 6, v244
    v_mfma_f32_4x4x4_16b_bf16 v[168:171], a[6:7], v[208:209], v[168:171]
    v_bfe_u32 v245, v1, 4, 1
    v_mfma_f32_4x4x4_16b_bf16 v[172:175], a[6:7], a[6:7], v[172:175]
    v_lshl_add_u32 v244, v245, 5, v244
    s_waitcnt lgkmcnt(4)
    v_mfma_f32_32x32x16_bf16 v[16:31], a[8:11], v[128:131], v[16:31]
    ds_read_b64_tr_b16 v[144:145], v215 offset:0
    ds_read_b64_tr_b16 v[146:147], v215 offset:256
    ds_read_b128 a[12:15], v219 offset:0
    v_mfma_f32_32x32x16_bf16 v[32:47], a[8:11], v[132:135], v[32:47]
    ds_read_b64_tr_b16 v[148:149], v215 offset:4096
    ds_read_b64_tr_b16 v[150:151], v215 offset:4352
    s_waitcnt lgkmcnt(5)
    v_mfma_f32_32x32x16_bf16 v[48:63], a[8:11], v[136:139], v[48:63]
    ds_read_b64_tr_b16 v[152:153], v215 offset:8192
    ds_read_b64_tr_b16 v[154:155], v215 offset:8448
    v_mfma_f32_32x32x16_bf16 v[64:79], a[8:11], v[140:143], v[64:79]
    s_waitcnt vmcnt(10)
    s_barrier
    s_add_u32 s39, s39, 0x20000000
    s_lshr_b32 s40, s39, 22
    s_mul_hi_u32 s41, s39, 1572864
    s_add_u32 m0, s46, 49152
    ds_read_b64_tr_b16 v[156:157], v215 offset:12288
    ds_read_b64_tr_b16 v[158:159], v215 offset:12544
    buffer_load_dwordx4 v228, s[4:7], s40 offen lds
    v_mfma_f32_4x4x4_16b_bf16 v[160:163], a[8:9], v[208:209], v[160:163]
    v_and_b32 v245, 3, v1
    v_mfma_f32_4x4x4_16b_bf16 v[164:167], a[8:9], a[8:9], v[164:167]
    v_lshl_add_u32 v244, v245, 3, v244
    v_mfma_f32_4x4x4_16b_bf16 v[168:171], a[10:11], v[208:209], v[168:171]
    v_add_u32 v12, s3, v244
    v_mfma_f32_4x4x4_16b_bf16 v[172:175], a[10:11], a[10:11], v[172:175]
    s_mul_i32 s60, s36, 28672
    s_waitcnt lgkmcnt(4)
    v_mfma_f32_32x32x16_bf16 v[16:31], a[12:15], v[144:147], v[16:31]
    s_add_u32 m0, s46, 50176
    ds_read_b64_tr_b16 v[128:129], v212 offset:16384
    ds_read_b64_tr_b16 v[130:131], v212 offset:16640
    ds_read_b128 a[16:19], v216 offset:16384
    buffer_load_dwordx4 v229, s[4:7], s40 offen lds
    v_mfma_f32_32x32x16_bf16 v[32:47], a[12:15], v[148:151], v[32:47]
    s_add_u32 m0, s46, 51200
    ds_read_b64_tr_b16 v[132:133], v212 offset:20480
    ds_read_b64_tr_b16 v[134:135], v212 offset:20736
    buffer_load_dwordx4 v230, s[4:7], s40 offen lds
    s_waitcnt lgkmcnt(5)
    v_mfma_f32_32x32x16_bf16 v[48:63], a[12:15], v[152:155], v[48:63]
    s_add_u32 m0, s46, 52224
    ds_read_b64_tr_b16 v[136:137], v212 offset:24576
    ds_read_b64_tr_b16 v[138:139], v212 offset:24832
    buffer_load_dwordx4 v231, s[4:7], s40 offen lds
    v_mfma_f32_32x32x16_bf16 v[64:79], a[12:15], v[156:159], v[64:79]
    s_add_u32 m0, s43, 49152
    ds_read_b64_tr_b16 v[140:141], v212 offset:28672
    ds_read_b64_tr_b16 v[142:143], v212 offset:28928
    buffer_load_dwordx4 v220, s[8:11], s41 offen lds
    v_mfma_f32_4x4x4_16b_bf16 v[160:163], a[12:13], v[208:209], v[160:163]
    s_and_b32 s58, s64, 3
    v_mfma_f32_4x4x4_16b_bf16 v[164:167], a[12:13], a[12:13], v[164:167]
    s_mul_i32 s58, s58, 3
    v_mfma_f32_4x4x4_16b_bf16 v[168:171], a[14:15], v[208:209], v[168:171]
    s_and_b32 s59, s65, 7
    v_mfma_f32_4x4x4_16b_bf16 v[172:175], a[14:15], a[14:15], v[172:175]
    s_mul_i32 s59, s59, 3
    s_waitcnt lgkmcnt(4)
    v_mfma_f32_32x32x16_bf16 v[16:31], a[16:19], v[128:131], v[16:31]
    s_add_u32 m0, s43, 53248
    ds_read_b64_tr_b16 v[144:145], v213 offset:16384
    ds_read_b64_tr_b16 v[146:147], v213 offset:16640
    ds_read_b128 a[20:23], v217 offset:16384
    buffer_load_dwordx4 v221, s[8:11], s41 offen lds
    v_mfma_f32_16x16x32_bf16 v[176:179], v[204:207], v[128:131], v[176:179]
    s_lshl_b32 s56, s38, 4
    s_add_u32 s56, s56, s37
    s_lshl_b32 s56, s56, 2
    s_add_u32 s56, s56, s36
    s_lshl_b32 s56, s56, 7
    v_lshlrev_b32 v232, 2, v1
    v_add_u32 v232, 13631488, v232
    s_mov_b64 exec, s[100:101]
    buffer_store_dword v243, v232, s[28:31], s56 offen sc1
    s_mov_b64 exec, -1
    s_lshr_b32 s59, s59, 1
    s_add_u32 s58, s58, s59
    v_mfma_f32_32x32x16_bf16 v[32:47], a[16:19], v[132:135], v[32:47]
    s_add_u32 m0, s43, 57344
    ds_read_b64_tr_b16 v[148:149], v213 offset:20480
    ds_read_b64_tr_b16 v[150:151], v213 offset:20736
    buffer_load_dwordx4 v222, s[8:11], s41 offen lds
    v_mfma_f32_16x16x32_bf16 v[180:183], v[204:207], v[132:135], v[180:183]
    s_cmp_ge_u32 s58, 12
    s_cselect_b32 s59, 12, 0
    s_sub_u32 s58, s58, s59
    s_waitcnt lgkmcnt(5)
    v_mfma_f32_32x32x16_bf16 v[48:63], a[16:19], v[136:139], v[48:63]
    s_add_u32 m0, s43, 61440
    ds_read_b64_tr_b16 v[152:153], v213 offset:24576
    ds_read_b64_tr_b16 v[154:155], v213 offset:24832
    buffer_load_dwordx4 v223, s[8:11], s41 offen lds
    v_mfma_f32_16x16x32_bf16 v[184:187], v[204:207], v[136:139], v[184:187]
    s_lshl_b32 s58, s58, 10
    s_add_u32 s70, s58, s60
    v_mfma_f32_32x32x16_bf16 v[64:79], a[16:19], v[140:143], v[64:79]
    ds_read_b64_tr_b16 v[156:157], v213 offset:28672
    ds_read_b64_tr_b16 v[158:159], v213 offset:28928
    v_mfma_f32_16x16x32_bf16 v[188:191], v[204:207], v[140:143], v[188:191]
    s_add_u32 s61, s60, 12288
    s_add_u32 s71, s70, 1024
    v_mfma_f32_4x4x4_16b_bf16 v[160:163], a[16:17], v[208:209], v[160:163]
    s_cmp_eq_u32 s71, s61
    s_cselect_b32 s71, s60, s71
    v_mfma_f32_4x4x4_16b_bf16 v[164:167], a[16:17], a[16:17], v[164:167]
    s_add_u32 s72, s71, 1024
    v_mfma_f32_4x4x4_16b_bf16 v[168:171], a[18:19], v[208:209], v[168:171]
    s_cmp_eq_u32 s72, s61
    s_cselect_b32 s72, s60, s72
    v_mfma_f32_4x4x4_16b_bf16 v[172:175], a[18:19], a[18:19], v[172:175]
    s_add_u32 s73, s72, 1024
    s_waitcnt lgkmcnt(4)
    v_mfma_f32_32x32x16_bf16 v[16:31], a[20:23], v[144:147], v[16:31]
    ds_read_b64_tr_b16 v[128:129], v214 offset:16384
    ds_read_b64_tr_b16 v[130:131], v214 offset:16640
    ds_read_b128 a[24:27], v218 offset:16384
    s_cmp_eq_u32 s73, s61
    s_cselect_b32 s73, s60, s73
    v_mfma_f32_32x32x16_bf16 v[32:47], a[20:23], v[148:151], v[32:47]
    ds_read_b64_tr_b16 v[132:133], v214 offset:20480
    ds_read_b64_tr_b16 v[134:135], v214 offset:20736
    s_add_u32 s74, s73, 1024
    s_waitcnt lgkmcnt(5)
    v_mfma_f32_32x32x16_bf16 v[48:63], a[20:23], v[152:155], v[48:63]
    ds_read_b64_tr_b16 v[136:137], v214 offset:24576
    ds_read_b64_tr_b16 v[138:139], v214 offset:24832
    s_cmp_eq_u32 s74, s61
    s_cselect_b32 s74, s60, s74
    v_mfma_f32_32x32x16_bf16 v[64:79], a[20:23], v[156:159], v[64:79]
    ds_read_b64_tr_b16 v[140:141], v214 offset:28672
    ds_read_b64_tr_b16 v[142:143], v214 offset:28928
    s_add_u32 s75, s74, 1024
    v_mfma_f32_4x4x4_16b_bf16 v[160:163], a[20:21], v[208:209], v[160:163]
    s_cmp_eq_u32 s75, s61
    s_cselect_b32 s75, s60, s75
    v_mfma_f32_4x4x4_16b_bf16 v[164:167], a[20:21], a[20:21], v[164:167]
    s_add_u32 s76, s75, 1024
    v_mfma_f32_4x4x4_16b_bf16 v[168:171], a[22:23], v[208:209], v[168:171]
    s_cmp_eq_u32 s76, s61
    s_cselect_b32 s76, s60, s76
    v_mfma_f32_4x4x4_16b_bf16 v[172:175], a[22:23], a[22:23], v[172:175]
    s_add_u32 s77, s76, 1024
    s_waitcnt lgkmcnt(4)
    v_mfma_f32_32x32x16_bf16 v[16:31], a[24:27], v[128:131], v[16:31]
    ds_read_b64_tr_b16 v[144:145], v215 offset:16384
    ds_read_b64_tr_b16 v[146:147], v215 offset:16640
    ds_read_b128 a[28:31], v219 offset:16384
    v_mfma_f32_32x32x16_bf16 v[32:47], a[24:27], v[132:135], v[32:47]
    ds_read_b64_tr_b16 v[148:149], v215 offset:20480
    ds_read_b64_tr_b16 v[150:151], v215 offset:20736
    s_waitcnt lgkmcnt(5)
    v_mfma_f32_32x32x16_bf16 v[48:63], a[24:27], v[136:139], v[48:63]
    ds_read_b64_tr_b16 v[152:153], v215 offset:24576
    ds_read_b64_tr_b16 v[154:155], v215 offset:24832
    v_mfma_f32_32x32x16_bf16 v[64:79], a[24:27], v[140:143], v[64:79]
    s_waitcnt vmcnt(11)
    s_barrier
    s_add_u32 s39, s39, 0x20000000
    s_lshr_b32 s40, s39, 22
    s_mul_hi_u32 s41, s39, 1572864
    s_add_u32 m0, s46, 0
    ds_read_b64_tr_b16 v[156:157], v215 offset:28672
    ds_read_b64_tr_b16 v[158:159], v215 offset:28928
    buffer_load_dwordx4 v228, s[4:7], s40 offen lds
    v_mfma_f32_4x4x4_16b_bf16 v[160:163], a[24:25], v[208:209], v[160:163]
    s_cmp_eq_u32 s77, s61
    s_cselect_b32 s77, s60, s77
    v_mfma_f32_4x4x4_16b_bf16 v[164:167], a[24:25], a[24:25], v[164:167]
    s_add_u32 s78, s77, 1024
    v_mfma_f32_4x4x4_16b_bf16 v[168:171], a[26:27], v[208:209], v[168:171]
    s_cmp_eq_u32 s78, s61
    s_cselect_b32 s78, s60, s78
    v_mfma_f32_4x4x4_16b_bf16 v[172:175], a[26:27], a[26:27], v[172:175]
    s_add_u32 s79, s78, 1024
    s_waitcnt lgkmcnt(4)
    v_mfma_f32_32x32x16_bf16 v[16:31], a[28:31], v[144:147], v[16:31]
    s_add_u32 m0, s46, 1024
    ds_read_b64_tr_b16 v[128:129], v212 offset:32768
    ds_read_b64_tr_b16 v[130:131], v212 offset:33024
    ds_read_b128 a[32:35], v216 offset:32768
    buffer_load_dwordx4 v229, s[4:7], s40 offen lds
    v_mfma_f32_32x32x16_bf16 v[32:47], a[28:31], v[148:151], v[32:47]
    s_add_u32 m0, s46, 2048
    ds_read_b64_tr_b16 v[132:133], v212 offset:36864
    ds_read_b64_tr_b16 v[134:135], v212 offset:37120
    buffer_load_dwordx4 v230, s[4:7], s40 offen lds
    s_waitcnt lgkmcnt(5)
    v_mfma_f32_32x32x16_bf16 v[48:63], a[28:31], v[152:155], v[48:63]
    s_add_u32 m0, s46, 3072
    ds_read_b64_tr_b16 v[136:137], v212 offset:40960
    ds_read_b64_tr_b16 v[138:139], v212 offset:41216
    buffer_load_dwordx4 v231, s[4:7], s40 offen lds
    v_mfma_f32_32x32x16_bf16 v[64:79], a[28:31], v[156:159], v[64:79]
    s_add_u32 m0, s43, 0
    ds_read_b64_tr_b16 v[140:141], v212 offset:45056
    ds_read_b64_tr_b16 v[142:143], v212 offset:45312
    buffer_load_dwordx4 v220, s[8:11], s41 offen lds
    v_mfma_f32_4x4x4_16b_bf16 v[160:163], a[28:29], v[208:209], v[160:163]
    s_cmp_eq_u32 s79, s61
    s_cselect_b32 s79, s60, s79
    v_mfma_f32_4x4x4_16b_bf16 v[164:167], a[28:29], a[28:29], v[164:167]
    s_add_u32 s80, s79, 1024
    v_mfma_f32_4x4x4_16b_bf16 v[168:171], a[30:31], v[208:209], v[168:171]
    s_cmp_eq_u32 s80, s61
    s_cselect_b32 s80, s60, s80
    v_mfma_f32_4x4x4_16b_bf16 v[172:175], a[30:31], a[30:31], v[172:175]
    s_add_u32 s81, s80, 1024
    s_waitcnt lgkmcnt(4)
    v_mfma_f32_32x32x16_bf16 v[16:31], a[32:35], v[128:131], v[16:31]
    s_add_u32 m0, s43, 4096
    ds_read_b64_tr_b16 v[144:145], v213 offset:32768
    ds_read_b64_tr_b16 v[146:147], v213 offset:33024
    ds_read_b128 a[36:39], v217 offset:32768
    buffer_load_dwordx4 v221, s[8:11], s41 offen lds
    v_mfma_f32_16x16x32_bf16 v[176:179], v[204:207], v[128:131], v[176:179]
    s_cmp_eq_u32 s81, s61
    s_cselect_b32 s81, s60, s81
    s_and_b32 s58, s64, 3
    v_mfma_f32_32x32x16_bf16 v[32:47], a[32:35], v[132:135], v[32:47]
    s_add_u32 m0, s43, 8192
    ds_read_b64_tr_b16 v[148:149], v213 offset:36864
    ds_read_b64_tr_b16 v[150:151], v213 offset:37120
    buffer_load_dwordx4 v222, s[8:11], s41 offen lds
    v_mfma_f32_16x16x32_bf16 v[180:183], v[204:207], v[132:135], v[180:183]
    s_lshl_b32 s58, s58, 1
    s_add_u32 s58, s58, s65
    s_waitcnt lgkmcnt(5)
    v_mfma_f32_32x32x16_bf16 v[48:63], a[32:35], v[136:139], v[48:63]
    s_add_u32 m0, s43, 12288
    ds_read_b64_tr_b16 v[152:153], v213 offset:40960
    ds_read_b64_tr_b16 v[154:155], v213 offset:41216
    buffer_load_dwordx4 v223, s[8:11], s41 offen lds
    v_mfma_f32_16x16x32_bf16 v[184:187], v[204:207], v[136:139], v[184:187]
    s_lshl_b32 s58, s58, 11
    s_and_b32 s58, s58, 0x3c00
    v_mfma_f32_32x32x16_bf16 v[64:79], a[32:35], v[140:143], v[64:79]
    ds_read_b64_tr_b16 v[156:157], v213 offset:45056
    ds_read_b64_tr_b16 v[158:159], v213 offset:45312
    v_mfma_f32_16x16x32_bf16 v[188:191], v[204:207], v[140:143], v[188:191]
    s_add_u32 s82, s58, s61
    s_add_u32 s58, s58, 1024
    v_mfma_f32_4x4x4_16b_bf16 v[160:163], a[32:33], v[208:209], v[160:163]
    s_and_b32 s58, s58, 0x3c00
    v_mfma_f32_4x4x4_16b_bf16 v[164:167], a[32:33], a[32:33], v[164:167]
    s_add_u32 s83, s58, s61
    v_mfma_f32_4x4x4_16b_bf16 v[168:171], a[34:35], v[208:209], v[168:171]
    s_add_u32 s58, s58, 1024
    v_mfma_f32_4x4x4_16b_bf16 v[172:175], a[34:35], a[34:35], v[172:175]
    s_and_b32 s58, s58, 0x3c00
    s_waitcnt lgkmcnt(4)
    v_mfma_f32_32x32x16_bf16 v[16:31], a[36:39], v[144:147], v[16:31]
    ds_read_b64_tr_b16 v[128:129], v214 offset:32768
    ds_read_b64_tr_b16 v[130:131], v214 offset:33024
    ds_read_b128 a[40:43], v218 offset:32768
    s_add_u32 s84, s58, s61
    v_mfma_f32_32x32x16_bf16 v[32:47], a[36:39], v[148:151], v[32:47]
    ds_read_b64_tr_b16 v[132:133], v214 offset:36864
    ds_read_b64_tr_b16 v[134:135], v214 offset:37120
    s_add_u32 s58, s58, 1024
    s_waitcnt lgkmcnt(5)
    v_mfma_f32_32x32x16_bf16 v[48:63], a[36:39], v[152:155], v[48:63]
    ds_read_b64_tr_b16 v[136:137], v214 offset:40960
    ds_read_b64_tr_b16 v[138:139], v214 offset:41216
    s_and_b32 s58, s58, 0x3c00
    v_mfma_f32_32x32x16_bf16 v[64:79], a[36:39], v[156:159], v[64:79]
    ds_read_b64_tr_b16 v[140:141], v214 offset:45056
    ds_read_b64_tr_b16 v[142:143], v214 offset:45312
    s_add_u32 s85, s58, s61
    v_mfma_f32_4x4x4_16b_bf16 v[160:163], a[36:37], v[208:209], v[160:163]
    s_add_u32 s58, s58, 1024
    v_mfma_f32_4x4x4_16b_bf16 v[164:167], a[36:37], a[36:37], v[164:167]
    s_and_b32 s58, s58, 0x3c00
    v_mfma_f32_4x4x4_16b_bf16 v[168:171], a[38:39], v[208:209], v[168:171]
    s_add_u32 s86, s58, s61
    v_mfma_f32_4x4x4_16b_bf16 v[172:175], a[38:39], a[38:39], v[172:175]
    s_add_u32 s58, s58, 1024
    s_waitcnt lgkmcnt(4)
    v_mfma_f32_32x32x16_bf16 v[16:31], a[40:43], v[128:131], v[16:31]
    ds_read_b64_tr_b16 v[144:145], v215 offset:32768
    ds_read_b64_tr_b16 v[146:147], v215 offset:33024
    ds_read_b128 a[44:47], v219 offset:32768
    v_mfma_f32_32x32x16_bf16 v[32:47], a[40:43], v[132:135], v[32:47]
    ds_read_b64_tr_b16 v[148:149], v215 offset:36864
    ds_read_b64_tr_b16 v[150:151], v215 offset:37120
    s_waitcnt lgkmcnt(5)
    v_mfma_f32_32x32x16_bf16 v[48:63], a[40:43], v[136:139], v[48:63]
    ds_read_b64_tr_b16 v[152:153], v215 offset:40960
    ds_read_b64_tr_b16 v[154:155], v215 offset:41216
    v_mfma_f32_32x32x16_bf16 v[64:79], a[40:43], v[140:143], v[64:79]
    s_waitcnt vmcnt(8)
    s_barrier
    s_add_u32 s39, s39, 0x20000000
    s_lshr_b32 s40, s39, 22
    s_mul_hi_u32 s41, s39, 1572864
    s_add_u32 m0, s46, 16384
    ds_read_b64_tr_b16 v[156:157], v215 offset:45056
    ds_read_b64_tr_b16 v[158:159], v215 offset:45312
    buffer_load_dwordx4 v228, s[4:7], s40 offen lds
    v_mfma_f32_4x4x4_16b_bf16 v[160:163], a[40:41], v[208:209], v[160:163]
    s_and_b32 s58, s58, 0x3c00
    v_mfma_f32_4x4x4_16b_bf16 v[164:167], a[40:41], a[40:41], v[164:167]
    s_add_u32 s87, s58, s61
    v_mfma_f32_4x4x4_16b_bf16 v[168:171], a[42:43], v[208:209], v[168:171]
    s_add_u32 s58, s58, 1024
    v_mfma_f32_4x4x4_16b_bf16 v[172:175], a[42:43], a[42:43], v[172:175]
    s_and_b32 s58, s58, 0x3c00
    s_waitcnt lgkmcnt(4)
    v_mfma_f32_32x32x16_bf16 v[16:31], a[44:47], v[144:147], v[16:31]
    s_add_u32 m0, s46, 17408
    ds_read_b64_tr_b16 v[128:129], v212 offset:49152
    ds_read_b64_tr_b16 v[130:131], v212 offset:49408
    ds_read_b128 a[48:51], v216 offset:49152
    buffer_load_dwordx4 v229, s[4:7], s40 offen lds
    v_mfma_f32_32x32x16_bf16 v[32:47], a[44:47], v[148:151], v[32:47]
    s_add_u32 m0, s46, 18432
    ds_read_b64_tr_b16 v[132:133], v212 offset:53248
    ds_read_b64_tr_b16 v[134:135], v212 offset:53504
    buffer_load_dwordx4 v230, s[4:7], s40 offen lds
    s_waitcnt lgkmcnt(5)
    v_mfma_f32_32x32x16_bf16 v[48:63], a[44:47], v[152:155], v[48:63]
    s_add_u32 m0, s46, 19456
    ds_read_b64_tr_b16 v[136:137], v212 offset:57344
    ds_read_b64_tr_b16 v[138:139], v212 offset:57600
    buffer_load_dwordx4 v231, s[4:7], s40 offen lds
    v_mfma_f32_32x32x16_bf16 v[64:79], a[44:47], v[156:159], v[64:79]
    s_add_u32 m0, s43, 16384
    ds_read_b64_tr_b16 v[140:141], v212 offset:61440
    ds_read_b64_tr_b16 v[142:143], v212 offset:61696
    buffer_load_dwordx4 v220, s[8:11], s41 offen lds
    v_mfma_f32_4x4x4_16b_bf16 v[160:163], a[44:45], v[208:209], v[160:163]
    s_add_u32 s88, s58, s61
    v_mfma_f32_4x4x4_16b_bf16 v[164:167], a[44:45], a[44:45], v[164:167]
    s_add_u32 s58, s58, 1024
    v_mfma_f32_4x4x4_16b_bf16 v[168:171], a[46:47], v[208:209], v[168:171]
    s_and_b32 s58, s58, 0x3c00
    v_mfma_f32_4x4x4_16b_bf16 v[172:175], a[46:47], a[46:47], v[172:175]
    s_add_u32 s89, s58, s61
    s_waitcnt lgkmcnt(4)
    v_mfma_f32_32x32x16_bf16 v[16:31], a[48:51], v[128:131], v[16:31]
    s_add_u32 m0, s43, 20480
    ds_read_b64_tr_b16 v[144:145], v213 offset:49152
    ds_read_b64_tr_b16 v[146:147], v213 offset:49408
    ds_read_b128 a[52:55], v217 offset:49152
    buffer_load_dwordx4 v221, s[8:11], s41 offen lds
    v_mfma_f32_16x16x32_bf16 v[176:179], v[204:207], v[128:131], v[176:179]
    buffer_load_dwordx2 v[250:251], v243, s[32:35], 0 offen sc1
    s_add_u32 s58, s58, 1024
    s_and_b32 s58, s58, 0x3c00
    v_mfma_f32_32x32x16_bf16 v[32:47], a[48:51], v[132:135], v[32:47]
    s_add_u32 m0, s43, 24576
    ds_read_b64_tr_b16 v[148:149], v213 offset:53248
    ds_read_b64_tr_b16 v[150:151], v213 offset:53504
    buffer_load_dwordx4 v222, s[8:11], s41 offen lds
    v_mfma_f32_16x16x32_bf16 v[180:183], v[204:207], v[132:135], v[180:183]
    s_add_u32 s90, s58, s61
    s_add_u32 s58, s58, 1024
    s_waitcnt lgkmcnt(5)
    v_mfma_f32_32x32x16_bf16 v[48:63], a[48:51], v[136:139], v[48:63]
    s_add_u32 m0, s43, 28672
    ds_read_b64_tr_b16 v[152:153], v213 offset:57344
    ds_read_b64_tr_b16 v[154:155], v213 offset:57600
    buffer_load_dwordx4 v223, s[8:11], s41 offen lds
    v_mfma_f32_16x16x32_bf16 v[184:187], v[204:207], v[136:139], v[184:187]
    s_and_b32 s58, s58, 0x3c00
    s_add_u32 s91, s58, s61
    v_mfma_f32_32x32x16_bf16 v[64:79], a[48:51], v[140:143], v[64:79]
    ds_read_b64_tr_b16 v[156:157], v213 offset:61440
    ds_read_b64_tr_b16 v[158:159], v213 offset:61696
    v_mfma_f32_16x16x32_bf16 v[188:191], v[204:207], v[140:143], v[188:191]
    s_add_u32 s58, s58, 1024
    s_and_b32 s58, s58, 0x3c00
    v_mfma_f32_4x4x4_16b_bf16 v[160:163], a[48:49], v[208:209], v[160:163]
    s_add_u32 s92, s58, s61
    v_mfma_f32_4x4x4_16b_bf16 v[164:167], a[48:49], a[48:49], v[164:167]
    s_add_u32 s58, s58, 1024
    v_mfma_f32_4x4x4_16b_bf16 v[168:171], a[50:51], v[208:209], v[168:171]
    s_and_b32 s58, s58, 0x3c00
    v_mfma_f32_4x4x4_16b_bf16 v[172:175], a[50:51], a[50:51], v[172:175]
    s_add_u32 s93, s58, s61
    s_waitcnt lgkmcnt(4)
    v_mfma_f32_32x32x16_bf16 v[16:31], a[52:55], v[144:147], v[16:31]
    ds_read_b64_tr_b16 v[128:129], v214 offset:49152
    ds_read_b64_tr_b16 v[130:131], v214 offset:49408
    ds_read_b128 a[56:59], v218 offset:49152
    s_add_u32 s58, s58, 1024
    v_mfma_f32_32x32x16_bf16 v[32:47], a[52:55], v[148:151], v[32:47]
    ds_read_b64_tr_b16 v[132:133], v214 offset:53248
    ds_read_b64_tr_b16 v[134:135], v214 offset:53504
    s_and_b32 s58, s58, 0x3c00
    s_waitcnt lgkmcnt(5)
    v_mfma_f32_32x32x16_bf16 v[48:63], a[52:55], v[152:155], v[48:63]
    ds_read_b64_tr_b16 v[136:137], v214 offset:57344
    ds_read_b64_tr_b16 v[138:139], v214 offset:57600
    s_add_u32 s94, s58, s61
    v_mfma_f32_32x32x16_bf16 v[64:79], a[52:55], v[156:159], v[64:79]
    ds_read_b64_tr_b16 v[140:141], v214 offset:61440
    ds_read_b64_tr_b16 v[142:143], v214 offset:61696
    s_add_u32 s58, s58, 1024
    v_mfma_f32_4x4x4_16b_bf16 v[160:163], a[52:53], v[208:209], v[160:163]
    s_and_b32 s58, s58, 0x3c00
    v_mfma_f32_4x4x4_16b_bf16 v[164:167], a[52:53], a[52:53], v[164:167]
    s_add_u32 s95, s58, s61
    v_mfma_f32_4x4x4_16b_bf16 v[168:171], a[54:55], v[208:209], v[168:171]
    s_add_u32 s58, s58, 1024
    v_mfma_f32_4x4x4_16b_bf16 v[172:175], a[54:55], a[54:55], v[172:175]
    s_and_b32 s58, s58, 0x3c00
    s_waitcnt lgkmcnt(4)
    v_mfma_f32_32x32x16_bf16 v[16:31], a[56:59], v[128:131], v[16:31]
    ds_read_b64_tr_b16 v[144:145], v215 offset:49152
    ds_read_b64_tr_b16 v[146:147], v215 offset:49408
    ds_read_b128 a[60:63], v219 offset:49152
    v_mfma_f32_32x32x16_bf16 v[32:47], a[56:59], v[132:135], v[32:47]
    ds_read_b64_tr_b16 v[148:149], v215 offset:53248
    ds_read_b64_tr_b16 v[150:151], v215 offset:53504
    s_waitcnt lgkmcnt(5)
    v_mfma_f32_32x32x16_bf16 v[48:63], a[56:59], v[136:139], v[48:63]
    ds_read_b64_tr_b16 v[152:153], v215 offset:57344
    ds_read_b64_tr_b16 v[154:155], v215 offset:57600
    v_mfma_f32_32x32x16_bf16 v[64:79], a[56:59], v[140:143], v[64:79]
    s_waitcnt vmcnt(9)
    s_barrier
    s_add_u32 s39, s39, 0x20000000
    s_lshr_b32 s40, s39, 22
    s_mul_hi_u32 s41, s39, 1572864
    s_add_u32 m0, s46, 32768
    ds_read_b64_tr_b16 v[156:157], v215 offset:61440
    ds_read_b64_tr_b16 v[158:159], v215 offset:61696
    buffer_load_dwordx4 v228, s[4:7], s40 offen lds
    v_mfma_f32_4x4x4_16b_bf16 v[160:163], a[56:57], v[208:209], v[160:163]
    s_add_u32 s96, s58, s61
    v_mfma_f32_4x4x4_16b_bf16 v[164:167], a[56:57], a[56:57], v[164:167]
    s_add_u32 s58, s58, 1024
    v_mfma_f32_4x4x4_16b_bf16 v[168:171], a[58:59], v[208:209], v[168:171]
    s_and_b32 s58, s58, 0x3c00
    v_mfma_f32_4x4x4_16b_bf16 v[172:175], a[58:59], a[58:59], v[172:175]
    s_add_u32 s97, s58, s61
    s_waitcnt lgkmcnt(4)
    v_mfma_f32_32x32x16_bf16 v[16:31], a[60:63], v[144:147], v[16:31]
    s_add_u32 m0, s46, 33792
    ds_read_b64_tr_b16 v[128:129], v212 offset:0
    ds_read_b64_tr_b16 v[130:131], v212 offset:256
    ds_read_b128 a[64:67], v216 offset:0
    buffer_load_dwordx4 v229, s[4:7], s40 offen lds
    v_mfma_f32_32x32x16_bf16 v[32:47], a[60:63], v[148:151], v[32:47]
    s_add_u32 m0, s46, 34816
    ds_read_b64_tr_b16 v[132:133], v212 offset:4096
    ds_read_b64_tr_b16 v[134:135], v212 offset:4352
    buffer_load_dwordx4 v230, s[4:7], s40 offen lds
    s_waitcnt lgkmcnt(5)
    v_mfma_f32_32x32x16_bf16 v[48:63], a[60:63], v[152:155], v[48:63]
    s_add_u32 m0, s46, 35840
    ds_read_b64_tr_b16 v[136:137], v212 offset:8192
    ds_read_b64_tr_b16 v[138:139], v212 offset:8448
    buffer_load_dwordx4 v231, s[4:7], s40 offen lds
    v_mfma_f32_32x32x16_bf16 v[64:79], a[60:63], v[156:159], v[64:79]
    s_add_u32 m0, s43, 32768
    ds_read_b64_tr_b16 v[140:141], v212 offset:12288
    ds_read_b64_tr_b16 v[142:143], v212 offset:12544
    buffer_load_dwordx4 v220, s[8:11], s41 offen lds
    v_mfma_f32_4x4x4_16b_bf16 v[160:163], a[60:61], v[208:209], v[160:163]
    v_lshlrev_b32 v80, 4, v1
    v_mfma_f32_4x4x4_16b_bf16 v[164:167], a[60:61], a[60:61], v[164:167]
    s_lshr_b32 s58, s36, 1
    v_mfma_f32_4x4x4_16b_bf16 v[168:171], a[62:63], v[208:209], v[168:171]
    s_lshl_b32 s60, s64, 1
    v_mfma_f32_4x4x4_16b_bf16 v[172:175], a[62:63], a[62:63], v[172:175]
    s_add_u32 s59, s60, s58
    s_waitcnt lgkmcnt(4)
    v_mfma_f32_32x32x16_bf16 v[16:31], a[64:67], v[128:131], v[16:31]
    s_add_u32 m0, s43, 36864
    ds_read_b64_tr_b16 v[144:145], v213 offset:0
    ds_read_b64_tr_b16 v[146:147], v213 offset:256
    ds_read_b128 a[68:71], v217 offset:0
    buffer_load_dwordx4 v221, s[8:11], s41 offen lds
    v_mfma_f32_16x16x32_bf16 v[176:179], v[204:207], v[128:131], v[176:179]
    s_xor_b32 s58, s58, 1
    s_add_u32 s58, s60, s58
    v_mfma_f32_32x32x16_bf16 v[32:47], a[64:67], v[132:135], v[32:47]
    s_add_u32 m0, s43, 40960
    ds_read_b64_tr_b16 v[148:149], v213 offset:4096
    ds_read_b64_tr_b16 v[150:151], v213 offset:4352
    buffer_load_dwordx4 v222, s[8:11], s41 offen lds
    v_mfma_f32_16x16x32_bf16 v[180:183], v[204:207], v[132:135], v[180:183]
    s_mul_i32 s60, s59, 114688
    v_add_u32 v234, s60, v80
    s_waitcnt lgkmcnt(5)
    v_mfma_f32_32x32x16_bf16 v[48:63], a[64:67], v[136:139], v[48:63]
    s_add_u32 m0, s43, 45056
    ds_read_b64_tr_b16 v[152:153], v213 offset:8192
    ds_read_b64_tr_b16 v[154:155], v213 offset:8448
    buffer_load_dwordx4 v223, s[8:11], s41 offen lds
    v_mfma_f32_16x16x32_bf16 v[184:187], v[204:207], v[136:139], v[184:187]
    s_mul_i32 s60, s58, 114688
    v_add_u32 v235, s60, v80
    v_mfma_f32_32x32x16_bf16 v[64:79], a[64:67], v[140:143], v[64:79]
    ds_read_b64_tr_b16 v[156:157], v213 offset:12288
    ds_read_b64_tr_b16 v[158:159], v213 offset:12544
    v_mfma_f32_16x16x32_bf16 v[188:191], v[204:207], v[140:143], v[188:191]
    s_lshl_b32 s61, s36, 13
    s_add_u32 s61, s61, 8388608
    v_mfma_f32_4x4x4_16b_bf16 v[160:163], a[64:65], v[208:209], v[160:163]
    s_lshl_b32 s60, s59, 15
    v_mfma_f32_4x4x4_16b_bf16 v[164:167], a[64:65], a[64:65], v[164:167]
    s_add_u32 s60, s60, s61
    v_mfma_f32_4x4x4_16b_bf16 v[168:171], a[66:67], v[208:209], v[168:171]
    v_add_u32 v236, s60, v80
    v_mfma_f32_4x4x4_16b_bf16 v[172:175], a[66:67], a[66:67], v[172:175]
    s_lshl_b32 s60, s58, 15
    s_waitcnt lgkmcnt(4)
    v_mfma_f32_32x32x16_bf16 v[16:31], a[68:71], v[144:147], v[16:31]
    ds_read_b64_tr_b16 v[128:129], v214 offset:0
    ds_read_b64_tr_b16 v[130:131], v214 offset:256
    ds_read_b128 a[72:75], v218 offset:0
    s_add_u32 s60, s60, s61
    v_mfma_f32_32x32x16_bf16 v[32:47], a[68:71], v[148:151], v[32:47]
    ds_read_b64_tr_b16 v[132:133], v214 offset:4096
    ds_read_b64_tr_b16 v[134:135], v214 offset:4352
    v_add_u32 v237, s60, v80
    s_waitcnt lgkmcnt(5)
    v_mfma_f32_32x32x16_bf16 v[48:63], a[68:71], v[152:155], v[48:63]
    ds_read_b64_tr_b16 v[136:137], v214 offset:8192
    ds_read_b64_tr_b16 v[138:139], v214 offset:8448
    s_lshl_b32 s61, s36, 14
    v_mfma_f32_32x32x16_bf16 v[64:79], a[68:71], v[156:159], v[64:79]
    ds_read_b64_tr_b16 v[140:141], v214 offset:12288
    ds_read_b64_tr_b16 v[142:143], v214 offset:12544
    s_add_u32 s61, s61, 13631488
    v_mfma_f32_4x4x4_16b_bf16 v[160:163], a[68:69], v[208:209], v[160:163]
    v_add_u32 v242, s61, v80
    v_mfma_f32_4x4x4_16b_bf16 v[164:167], a[68:69], a[68:69], v[164:167]
    s_lshr_b32 s60, s64, 1
    v_mfma_f32_4x4x4_16b_bf16 v[168:171], a[70:71], v[208:209], v[168:171]
    s_lshl_b32 s60, s60, 2
    v_mfma_f32_4x4x4_16b_bf16 v[172:175], a[70:71], a[70:71], v[172:175]
    s_add_u32 s60, s60, s36
    s_waitcnt lgkmcnt(4)
    v_mfma_f32_32x32x16_bf16 v[16:31], a[72:75], v[128:131], v[16:31]
    ds_read_b64_tr_b16 v[144:145], v215 offset:0
    ds_read_b64_tr_b16 v[146:147], v215 offset:256
    ds_read_b128 a[76:79], v219 offset:0
    v_mfma_f32_32x32x16_bf16 v[32:47], a[72:75], v[132:135], v[32:47]
    ds_read_b64_tr_b16 v[148:149], v215 offset:4096
    ds_read_b64_tr_b16 v[150:151], v215 offset:4352
    s_waitcnt lgkmcnt(5)
    v_mfma_f32_32x32x16_bf16 v[48:63], a[72:75], v[136:139], v[48:63]
    ds_read_b64_tr_b16 v[152:153], v215 offset:8192
    ds_read_b64_tr_b16 v[154:155], v215 offset:8448
    v_mfma_f32_32x32x16_bf16 v[64:79], a[72:75], v[140:143], v[64:79]
    s_waitcnt vmcnt(8)
    s_barrier
    s_add_u32 s39, s39, 0x20000000
    s_lshr_b32 s40, s39, 22
    s_mul_hi_u32 s41, s39, 1572864
    s_add_u32 m0, s46, 49152
    ds_read_b64_tr_b16 v[156:157], v215 offset:12288
    ds_read_b64_tr_b16 v[158:159], v215 offset:12544
    buffer_load_dwordx4 v228, s[4:7], s40 offen lds
    v_mfma_f32_4x4x4_16b_bf16 v[160:163], a[72:73], v[208:209], v[160:163]
    s_lshl_b32 s60, s60, 3
    v_mfma_f32_4x4x4_16b_bf16 v[164:167], a[72:73], a[72:73], v[164:167]
    s_and_b32 s61, s64, 1
    v_mfma_f32_4x4x4_16b_bf16 v[168:171], a[74:75], v[208:209], v[168:171]
    s_add_u32 s60, s60, s61
    v_mfma_f32_4x4x4_16b_bf16 v[172:175], a[74:75], a[74:75], v[172:175]
    s_lshl_b32 s60, s60, 8
    s_waitcnt lgkmcnt(4)
    v_mfma_f32_32x32x16_bf16 v[16:31], a[76:79], v[144:147], v[16:31]
    s_add_u32 m0, s46, 50176
    ds_read_b64_tr_b16 v[128:129], v212 offset:16384
    ds_read_b64_tr_b16 v[130:131], v212 offset:16640
    ds_read_b128 a[80:83], v216 offset:16384
    buffer_load_dwordx4 v229, s[4:7], s40 offen lds
    v_mfma_f32_32x32x16_bf16 v[32:47], a[76:79], v[148:151], v[32:47]
    s_add_u32 m0, s46, 51200
    ds_read_b64_tr_b16 v[132:133], v212 offset:20480
    ds_read_b64_tr_b16 v[134:135], v212 offset:20736
    buffer_load_dwordx4 v230, s[4:7], s40 offen lds
    s_waitcnt lgkmcnt(5)
    v_mfma_f32_32x32x16_bf16 v[48:63], a[76:79], v[152:155], v[48:63]
    s_add_u32 m0, s46, 52224
    ds_read_b64_tr_b16 v[136:137], v212 offset:24576
    ds_read_b64_tr_b16 v[138:139], v212 offset:24832
    buffer_load_dwordx4 v231, s[4:7], s40 offen lds
    v_mfma_f32_32x32x16_bf16 v[64:79], a[76:79], v[156:159], v[64:79]
    s_add_u32 m0, s43, 49152
    ds_read_b64_tr_b16 v[140:141], v212 offset:28672
    ds_read_b64_tr_b16 v[142:143], v212 offset:28928
    buffer_load_dwordx4 v220, s[8:11], s41 offen lds
    v_mfma_f32_4x4x4_16b_bf16 v[160:163], a[76:77], v[208:209], v[160:163]
    s_add_u32 s60, s60, 14680064
    v_mfma_f32_4x4x4_16b_bf16 v[164:167], a[76:77], a[76:77], v[164:167]
    v_bfe_u32 v81, v1, 1, 2
    v_mfma_f32_4x4x4_16b_bf16 v[168:171], a[78:79], v[208:209], v[168:171]
    v_lshlrev_b32 v81, 9, v81
    v_mfma_f32_4x4x4_16b_bf16 v[172:175], a[78:79], a[78:79], v[172:175]
    v_and_b32 v82, 1, v1
    s_waitcnt lgkmcnt(4)
    v_mfma_f32_32x32x16_bf16 v[16:31], a[80:83], v[128:131], v[16:31]
    s_add_u32 m0, s43, 53248
    ds_read_b64_tr_b16 v[144:145], v213 offset:16384
    ds_read_b64_tr_b16 v[146:147], v213 offset:16640
    ds_read_b128 a[84:87], v217 offset:16384
    buffer_load_dwordx4 v221, s[8:11], s41 offen lds
    v_mfma_f32_16x16x32_bf16 v[176:179], v[204:207], v[128:131], v[176:179]
    v_lshl_add_u32 v81, v82, 7, v81
    v_add_u32 v240, s60, v81
    v_mfma_f32_32x32x16_bf16 v[32:47], a[80:83], v[132:135], v[32:47]
    s_add_u32 m0, s43, 57344
    ds_read_b64_tr_b16 v[148:149], v213 offset:20480
    ds_read_b64_tr_b16 v[150:151], v213 offset:20736
    buffer_load_dwordx4 v222, s[8:11], s41 offen lds
    v_mfma_f32_16x16x32_bf16 v[180:183], v[204:207], v[132:135], v[180:183]
    v_or_b32 v81, 512, v81
    s_add_u32 s60, s60, 262144
    s_waitcnt lgkmcnt(5)
    v_mfma_f32_32x32x16_bf16 v[48:63], a[80:83], v[136:139], v[48:63]
    s_add_u32 m0, s43, 61440
    ds_read_b64_tr_b16 v[152:153], v213 offset:24576
    ds_read_b64_tr_b16 v[154:155], v213 offset:24832
    buffer_load_dwordx4 v223, s[8:11], s41 offen lds
    v_mfma_f32_16x16x32_bf16 v[184:187], v[204:207], v[136:139], v[184:187]
    v_add_u32 v233, s60, v81
    s_lshl_b32 s60, s36, 6
    v_mfma_f32_32x32x16_bf16 v[64:79], a[80:83], v[140:143], v[64:79]
    ds_read_b64_tr_b16 v[156:157], v213 offset:28672
    ds_read_b64_tr_b16 v[158:159], v213 offset:28928
    v_mfma_f32_16x16x32_bf16 v[188:191], v[204:207], v[140:143], v[188:191]
    s_and_b32 s61, s2, 31
    s_add_u32 s60, s60, s61
    v_mfma_f32_4x4x4_16b_bf16 v[160:163], a[80:81], v[208:209], v[160:163]
    s_lshl_b32 s60, s60, 7
    v_mfma_f32_4x4x4_16b_bf16 v[164:167], a[80:81], a[80:81], v[164:167]
    s_add_u32 s60, s60, 14876672
    v_mfma_f32_4x4x4_16b_bf16 v[168:171], a[82:83], v[208:209], v[168:171]
    v_lshl_add_u32 v241, v82, 12, s60
    v_mfma_f32_4x4x4_16b_bf16 v[172:175], a[82:83], a[82:83], v[172:175]
    s_lshl_b32 s60, s59, 15
    s_waitcnt lgkmcnt(4)
    v_mfma_f32_32x32x16_bf16 v[16:31], a[84:87], v[144:147], v[16:31]
    ds_read_b64_tr_b16 v[128:129], v214 offset:16384
    ds_read_b64_tr_b16 v[130:131], v214 offset:16640
    ds_read_b128 a[88:91], v218 offset:16384
    s_lshl_b32 s61, s65, 7
    v_mfma_f32_32x32x16_bf16 v[32:47], a[84:87], v[148:151], v[32:47]
    ds_read_b64_tr_b16 v[132:133], v214 offset:20480
    ds_read_b64_tr_b16 v[134:135], v214 offset:20736
    s_add_u32 s60, s60, s61
    s_waitcnt lgkmcnt(5)
    v_mfma_f32_32x32x16_bf16 v[48:63], a[84:87], v[152:155], v[48:63]
    ds_read_b64_tr_b16 v[136:137], v214 offset:24576
    ds_read_b64_tr_b16 v[138:139], v214 offset:24832
    s_and_b32 s61, s36, 1
    v_mfma_f32_32x32x16_bf16 v[64:79], a[84:87], v[156:159], v[64:79]
    ds_read_b64_tr_b16 v[140:141], v214 offset:28672
    ds_read_b64_tr_b16 v[142:143], v214 offset:28928
    s_lshl_b32 s61, s61, 6
    v_mfma_f32_4x4x4_16b_bf16 v[160:163], a[84:85], v[208:209], v[160:163]
    s_add_u32 s60, s60, s61
    v_mfma_f32_4x4x4_16b_bf16 v[164:167], a[84:85], a[84:85], v[164:167]
    v_lshrrev_b32 v80, 5, v1
    v_mfma_f32_4x4x4_16b_bf16 v[168:171], a[86:87], v[208:209], v[168:171]
    v_and_b32 v81, 31, v1
    v_mfma_f32_4x4x4_16b_bf16 v[172:175], a[86:87], a[86:87], v[172:175]
    v_lshlrev_b32 v82, 10, v81
    s_waitcnt lgkmcnt(4)
    v_mfma_f32_32x32x16_bf16 v[16:31], a[88:91], v[128:131], v[16:31]
    ds_read_b64_tr_b16 v[144:145], v215 offset:16384
    ds_read_b64_tr_b16 v[146:147], v215 offset:16640
    ds_read_b128 a[92:95], v219 offset:16384
    v_mfma_f32_32x32x16_bf16 v[32:47], a[88:91], v[132:135], v[32:47]
    ds_read_b64_tr_b16 v[148:149], v215 offset:20480
    ds_read_b64_tr_b16 v[150:151], v215 offset:20736
    s_waitcnt lgkmcnt(5)
    v_mfma_f32_32x32x16_bf16 v[48:63], a[88:91], v[136:139], v[48:63]
    ds_read_b64_tr_b16 v[152:153], v215 offset:24576
    ds_read_b64_tr_b16 v[154:155], v215 offset:24832
    v_mfma_f32_32x32x16_bf16 v[64:79], a[88:91], v[140:143], v[64:79]
    s_waitcnt vmcnt(8)
    s_barrier
    s_add_u32 s39, s39, 0x20000000
    s_mul_hi_u32 s42, s39, 1835008
    s_add_u32 m0, s43, 0
    ds_read_b64_tr_b16 v[156:157], v215 offset:28672
    ds_read_b64_tr_b16 v[158:159], v215 offset:28928
    buffer_load_dwordx4 v224, s[12:15], s42 offen lds
    v_mfma_f32_4x4x4_16b_bf16 v[160:163], a[88:89], v[208:209], v[160:163]
    s_lshl_b32 s41, s37, 4
    v_mfma_f32_4x4x4_16b_bf16 v[164:167], a[88:89], a[88:89], v[164:167]
    s_lshl_b32 s40, s38, 1
    v_mfma_f32_4x4x4_16b_bf16 v[168:171], a[90:91], v[208:209], v[168:171]
    s_add_u32 s41, s41, s40
    v_mfma_f32_4x4x4_16b_bf16 v[172:175], a[90:91], a[90:91], v[172:175]
    s_lshl_b32 s41, s41, 2
    s_waitcnt lgkmcnt(4)
    v_mfma_f32_32x32x16_bf16 v[16:31], a[92:95], v[144:147], v[16:31]
    s_add_u32 m0, s43, 4096
    ds_read_b64_tr_b16 v[128:129], v212 offset:32768
    ds_read_b64_tr_b16 v[130:131], v212 offset:33024
    ds_read_b128 a[96:99], v216 offset:32768
    buffer_load_dwordx4 v225, s[12:15], s42 offen lds
    v_mfma_f32_32x32x16_bf16 v[32:47], a[92:95], v[148:151], v[32:47]
    ds_read_b64_tr_b16 v[132:133], v212 offset:36864
    ds_read_b64_tr_b16 v[134:135], v212 offset:37120
    s_waitcnt lgkmcnt(5)
    v_mfma_f32_32x32x16_bf16 v[48:63], a[92:95], v[152:155], v[48:63]
    ds_read_b64_tr_b16 v[136:137], v212 offset:40960
    ds_read_b64_tr_b16 v[138:139], v212 offset:41216
    v_mfma_f32_32x32x16_bf16 v[64:79], a[92:95], v[156:159], v[64:79]
    ds_read_b64_tr_b16 v[140:141], v212 offset:45056
    ds_read_b64_tr_b16 v[142:143], v212 offset:45312
    v_mfma_f32_4x4x4_16b_bf16 v[160:163], a[92:93], v[208:209], v[160:163]
    s_add_u32 s41, s41, s36
    v_mfma_f32_4x4x4_16b_bf16 v[164:167], a[92:93], a[92:93], v[164:167]
    s_lshl_b32 s41, s41, 7
    v_mfma_f32_4x4x4_16b_bf16 v[168:171], a[94:95], v[208:209], v[168:171]
    s_lshl_b32 s40, s38, 4
    v_mfma_f32_4x4x4_16b_bf16 v[172:175], a[94:95], a[94:95], v[172:175]
    s_add_u32 s40, s40, s37
    s_waitcnt lgkmcnt(4)
    v_mfma_f32_32x32x16_bf16 v[16:31], a[96:99], v[128:131], v[16:31]
    ds_read_b64_tr_b16 v[144:145], v213 offset:32768
    ds_read_b64_tr_b16 v[146:147], v213 offset:33024
    ds_read_b128 a[100:103], v217 offset:32768
    v_mfma_f32_16x16x32_bf16 v[176:179], v[204:207], v[128:131], v[176:179]
    v_readfirstlane_b32 s44, v250
    v_readfirstlane_b32 s45, v251
    s_cmp_lg_u32 s44, 0
    s_cbranch_scc1 nond_3
    s_mov_b32 s67, 0x8000
non_2:
    buffer_load_dwordx2 v[250:251], v243, s[32:35], 0 offen sc1
    s_waitcnt vmcnt(0)
    v_readfirstlane_b32 s44, v250
    v_readfirstlane_b32 s45, v251
    s_cmp_lg_u32 s44, 0
    s_cbranch_scc1 nond_3
    s_sub_u32 s67, s67, 1
    s_cmp_lg_u32 s67, 0
    s_cbranch_scc1 non_2
nond_3:
    s_lshl_b32 s40, s40, 4
    s_add_u32 s40, s40, s36
    v_mfma_f32_32x32x16_bf16 v[32:47], a[96:99], v[132:135], v[32:47]
    ds_read_b64_tr_b16 v[148:149], v213 offset:36864
    ds_read_b64_tr_b16 v[150:151], v213 offset:37120
    v_mfma_f32_16x16x32_bf16 v[180:183], v[204:207], v[132:135], v[180:183]
    s_lshl_b32 s40, s40, 3
    s_add_u32 s40, s40, 196608
    s_waitcnt lgkmcnt(5)
    v_mfma_f32_32x32x16_bf16 v[48:63], a[96:99], v[136:139], v[48:63]
    ds_read_b64_tr_b16 v[152:153], v213 offset:40960
    ds_read_b64_tr_b16 v[154:155], v213 offset:41216
    v_mfma_f32_16x16x32_bf16 v[184:187], v[204:207], v[136:139], v[184:187]
    v_lshl_add_u32 v82, v80, 3, v82
    v_add_u32 v239, s60, v82
    v_mfma_f32_32x32x16_bf16 v[64:79], a[96:99], v[140:143], v[64:79]
    ds_read_b64_tr_b16 v[156:157], v213 offset:45056
    ds_read_b64_tr_b16 v[158:159], v213 offset:45312
    v_mfma_f32_16x16x32_bf16 v[188:191], v[204:207], v[140:143], v[188:191]
    s_lshl_b32 s60, s59, 7
    s_lshl_b32 s61, s36, 14
    v_mfma_f32_4x4x4_16b_bf16 v[160:163], a[96:97], v[208:209], v[160:163]
    s_add_u32 s60, s60, s61
    v_mfma_f32_4x4x4_16b_bf16 v[164:167], a[96:97], a[96:97], v[164:167]
    s_add_u32 s60, s60, 13697024
    v_mfma_f32_4x4x4_16b_bf16 v[168:171], a[98:99], v[208:209], v[168:171]
    v_lshlrev_b32 v81, 2, v81
    v_mfma_f32_4x4x4_16b_bf16 v[172:175], a[98:99], a[98:99], v[172:175]
    v_add_u32 v253, s60, v81
    s_waitcnt lgkmcnt(4)
    v_mfma_f32_32x32x16_bf16 v[16:31], a[100:103], v[144:147], v[16:31]
    ds_read_b64_tr_b16 v[128:129], v214 offset:32768
    ds_read_b64_tr_b16 v[130:131], v214 offset:33024
    ds_read_b128 a[104:107], v218 offset:32768
    s_lshl_b32 s56, s38, 4
    s_add_u32 s56, s56, s37
    s_lshl_b32 s56, s56, 1
    s_and_b32 s57, s36, 1
    s_add_u32 s56, s56, s57
    s_lshl_b32 s56, s56, 7
    v_mov_b32 v246, s44
    v_mov_b32 v247, s45
    v_mov_b32 v248, 14876672
    s_mov_b64 exec, 1
    buffer_store_dwordx2 v[246:247], v248, s[28:31], s56 offen sc1
    s_mov_b64 exec, -1
    v_mfma_f32_32x32x16_bf16 v[32:47], a[100:103], v[148:151], v[32:47]
    ds_read_b64_tr_b16 v[132:133], v214 offset:36864
    ds_read_b64_tr_b16 v[134:135], v214 offset:37120
    s_waitcnt lgkmcnt(5)
    v_mfma_f32_32x32x16_bf16 v[48:63], a[100:103], v[152:155], v[48:63]
    ds_read_b64_tr_b16 v[136:137], v214 offset:40960
    ds_read_b64_tr_b16 v[138:139], v214 offset:41216
    v_mfma_f32_32x32x16_bf16 v[64:79], a[100:103], v[156:159], v[64:79]
    ds_read_b64_tr_b16 v[140:141], v214 offset:45056
    ds_read_b64_tr_b16 v[142:143], v214 offset:45312
    v_mfma_f32_4x4x4_16b_bf16 v[160:163], a[100:101], v[208:209], v[160:163]
    v_mfma_f32_4x4x4_16b_bf16 v[164:167], a[100:101], a[100:101], v[164:167]
    v_mfma_f32_4x4x4_16b_bf16 v[168:171], a[102:103], v[208:209], v[168:171]
    v_mfma_f32_4x4x4_16b_bf16 v[172:175], a[102:103], a[102:103], v[172:175]
    s_waitcnt lgkmcnt(4)
    v_mfma_f32_32x32x16_bf16 v[16:31], a[104:107], v[128:131], v[16:31]
    ds_read_b64_tr_b16 v[144:145], v215 offset:32768
    ds_read_b64_tr_b16 v[146:147], v215 offset:33024
    ds_read_b128 a[108:111], v219 offset:32768
    v_mfma_f32_32x32x16_bf16 v[32:47], a[104:107], v[132:135], v[32:47]
    ds_read_b64_tr_b16 v[148:149], v215 offset:36864
    ds_read_b64_tr_b16 v[150:151], v215 offset:37120
    s_waitcnt lgkmcnt(5)
    v_mfma_f32_32x32x16_bf16 v[48:63], a[104:107], v[136:139], v[48:63]
    ds_read_b64_tr_b16 v[152:153], v215 offset:40960
    ds_read_b64_tr_b16 v[154:155], v215 offset:41216
    v_mfma_f32_32x32x16_bf16 v[64:79], a[104:107], v[140:143], v[64:79]
    s_waitcnt vmcnt(3)
    s_barrier
    s_add_u32 s39, s39, 0x20000000
    s_mul_hi_u32 s42, s39, 1835008
    s_add_u32 m0, s43, 16384
    ds_read_b64_tr_b16 v[156:157], v215 offset:45056
    ds_read_b64_tr_b16 v[158:159], v215 offset:45312
    buffer_load_dwordx4 v224, s[12:15], s42 offen lds
    v_mfma_f32_4x4x4_16b_bf16 v[160:163], a[104:105], v[208:209], v[160:163]
    v_mfma_f32_4x4x4_16b_bf16 v[164:167], a[104:105], a[104:105], v[164:167]
    v_mfma_f32_4x4x4_16b_bf16 v[168:171], a[106:107], v[208:209], v[168:171]
    v_mfma_f32_4x4x4_16b_bf16 v[172:175], a[106:107], a[106:107], v[172:175]
    s_waitcnt lgkmcnt(4)
    v_mfma_f32_32x32x16_bf16 v[16:31], a[108:111], v[144:147], v[16:31]
    s_add_u32 m0, s43, 20480
    ds_read_b64_tr_b16 v[128:129], v212 offset:49152
    ds_read_b64_tr_b16 v[130:131], v212 offset:49408
    ds_read_b128 a[112:115], v216 offset:49152
    buffer_load_dwordx4 v225, s[12:15], s42 offen lds
    v_mfma_f32_32x32x16_bf16 v[32:47], a[108:111], v[148:151], v[32:47]
    ds_read_b64_tr_b16 v[132:133], v212 offset:53248
    ds_read_b64_tr_b16 v[134:135], v212 offset:53504
    s_waitcnt lgkmcnt(5)
    v_mfma_f32_32x32x16_bf16 v[48:63], a[108:111], v[152:155], v[48:63]
    ds_read_b64_tr_b16 v[136:137], v212 offset:57344
    ds_read_b64_tr_b16 v[138:139], v212 offset:57600
    v_mfma_f32_32x32x16_bf16 v[64:79], a[108:111], v[156:159], v[64:79]
    ds_read_b64_tr_b16 v[140:141], v212 offset:61440
    ds_read_b64_tr_b16 v[142:143], v212 offset:61696
    v_mfma_f32_4x4x4_16b_bf16 v[160:163], a[108:109], v[208:209], v[160:163]
    v_mfma_f32_4x4x4_16b_bf16 v[164:167], a[108:109], a[108:109], v[164:167]
    v_mfma_f32_4x4x4_16b_bf16 v[168:171], a[110:111], v[208:209], v[168:171]
    v_mfma_f32_4x4x4_16b_bf16 v[172:175], a[110:111], a[110:111], v[172:175]
    s_waitcnt lgkmcnt(4)
    v_mfma_f32_32x32x16_bf16 v[16:31], a[112:115], v[128:131], v[16:31]
    ds_read_b64_tr_b16 v[144:145], v213 offset:49152
    ds_read_b64_tr_b16 v[146:147], v213 offset:49408
    ds_read_b128 a[116:119], v217 offset:49152
    v_mfma_f32_16x16x32_bf16 v[176:179], v[204:207], v[128:131], v[176:179]
    v_mfma_f32_32x32x16_bf16 v[32:47], a[112:115], v[132:135], v[32:47]
    ds_read_b64_tr_b16 v[148:149], v213 offset:53248
    ds_read_b64_tr_b16 v[150:151], v213 offset:53504
    v_mfma_f32_16x16x32_bf16 v[180:183], v[204:207], v[132:135], v[180:183]
    s_waitcnt lgkmcnt(5)
    v_mfma_f32_32x32x16_bf16 v[48:63], a[112:115], v[136:139], v[48:63]
    ds_read_b64_tr_b16 v[152:153], v213 offset:57344
    ds_read_b64_tr_b16 v[154:155], v213 offset:57600
    v_mfma_f32_16x16x32_bf16 v[184:187], v[204:207], v[136:139], v[184:187]
    v_mfma_f32_32x32x16_bf16 v[64:79], a[112:115], v[140:143], v[64:79]
    ds_read_b64_tr_b16 v[156:157], v213 offset:61440
    ds_read_b64_tr_b16 v[158:159], v213 offset:61696
    v_mfma_f32_16x16x32_bf16 v[188:191], v[204:207], v[140:143], v[188:191]
    v_mfma_f32_4x4x4_16b_bf16 v[160:163], a[112:113], v[208:209], v[160:163]
    v_mfma_f32_4x4x4_16b_bf16 v[164:167], a[112:113], a[112:113], v[164:167]
    v_mfma_f32_4x4x4_16b_bf16 v[168:171], a[114:115], v[208:209], v[168:171]
    v_mfma_f32_4x4x4_16b_bf16 v[172:175], a[114:115], a[114:115], v[172:175]
    s_waitcnt lgkmcnt(4)
    v_mfma_f32_32x32x16_bf16 v[16:31], a[116:119], v[144:147], v[16:31]
    ds_read_b64_tr_b16 v[128:129], v214 offset:49152
    ds_read_b64_tr_b16 v[130:131], v214 offset:49408
    ds_read_b128 a[120:123], v218 offset:49152
    v_mfma_f32_32x32x16_bf16 v[32:47], a[116:119], v[148:151], v[32:47]
    ds_read_b64_tr_b16 v[132:133], v214 offset:53248
    ds_read_b64_tr_b16 v[134:135], v214 offset:53504
    v_cvt_pk_bf16_f32 v177, v176, v176
    v_cvt_pk_bf16_f32 v181, v180, v180
    s_waitcnt lgkmcnt(5)
    v_mfma_f32_32x32x16_bf16 v[48:63], a[116:119], v[152:155], v[48:63]
    ds_read_b64_tr_b16 v[136:137], v214 offset:57344
    ds_read_b64_tr_b16 v[138:139], v214 offset:57600
    v_cvt_pk_bf16_f32 v185, v184, v184
    v_cvt_pk_bf16_f32 v189, v188, v188
    v_mfma_f32_32x32x16_bf16 v[64:79], a[116:119], v[156:159], v[64:79]
    ds_read_b64_tr_b16 v[140:141], v214 offset:61440
    ds_read_b64_tr_b16 v[142:143], v214 offset:61696
    v_and_b32 v177, s69, v177
    v_and_b32 v181, s69, v181
    v_mfma_f32_4x4x4_16b_bf16 v[160:163], a[116:117], v[208:209], v[160:163]
    v_mfma_f32_4x4x4_16b_bf16 v[164:167], a[116:117], a[116:117], v[164:167]
    v_mfma_f32_4x4x4_16b_bf16 v[168:171], a[118:119], v[208:209], v[168:171]
    v_mfma_f32_4x4x4_16b_bf16 v[172:175], a[118:119], a[118:119], v[172:175]
    s_waitcnt lgkmcnt(4)
    v_mfma_f32_32x32x16_bf16 v[16:31], a[120:123], v[128:131], v[16:31]
    s_waitcnt vmcnt(3)
    s_barrier
    s_add_u32 s39, s39, 0x20000000
    s_mul_hi_u32 s42, s39, 1835008
    s_add_u32 m0, s43, 32768
    ds_read_b64_tr_b16 v[144:145], v215 offset:49152
    ds_read_b64_tr_b16 v[146:147], v215 offset:49408
    ds_read_b128 a[124:127], v219 offset:49152
    buffer_load_dwordx4 v224, s[12:15], s42 offen lds
    v_and_b32 v185, s69, v185
    v_and_b32 v189, s69, v189
    v_mfma_f32_32x32x16_bf16 v[32:47], a[120:123], v[132:135], v[32:47]
    s_add_u32 m0, s43, 36864
    ds_read_b64_tr_b16 v[148:149], v215 offset:53248
    ds_read_b64_tr_b16 v[150:151], v215 offset:53504
    buffer_load_dwordx4 v225, s[12:15], s42 offen lds
    v_sub_f32 v177, v176, v177
    v_sub_f32 v181, v180, v181
    s_waitcnt lgkmcnt(5)
    v_mfma_f32_32x32x16_bf16 v[48:63], a[120:123], v[136:139], v[48:63]
    ds_read_b64_tr_b16 v[152:153], v215 offset:57344
    ds_read_b64_tr_b16 v[154:155], v215 offset:57600
    v_sub_f32 v185, v184, v185
    v_sub_f32 v189, v188, v189
    v_mfma_f32_32x32x16_bf16 v[64:79], a[120:123], v[140:143], v[64:79]
    ds_read_b64_tr_b16 v[156:157], v215 offset:61440
    ds_read_b64_tr_b16 v[158:159], v215 offset:61696
    v_cvt_pk_bf16_f32 v176, v176, v177
    v_cvt_pk_bf16_f32 v180, v180, v181
    v_mfma_f32_4x4x4_16b_bf16 v[160:163], a[120:121], v[208:209], v[160:163]
    v_mfma_f32_4x4x4_16b_bf16 v[164:167], a[120:121], a[120:121], v[164:167]
    v_mfma_f32_4x4x4_16b_bf16 v[168:171], a[122:123], v[208:209], v[168:171]
    v_mfma_f32_4x4x4_16b_bf16 v[172:175], a[122:123], a[122:123], v[172:175]
    s_waitcnt lgkmcnt(4)
    v_mfma_f32_32x32x16_bf16 v[16:31], a[124:127], v[144:147], v[16:31]
    ds_read_b64_tr_b16 v[128:129], v212 offset:0
    ds_read_b64_tr_b16 v[130:131], v212 offset:256
    v_cvt_pk_bf16_f32 v184, v184, v185
    v_cvt_pk_bf16_f32 v188, v188, v189
    v_mfma_f32_32x32x16_bf16 v[32:47], a[124:127], v[148:151], v[32:47]
    ds_read_b64_tr_b16 v[132:133], v212 offset:4096
    ds_read_b64_tr_b16 v[134:135], v212 offset:4352
    ds_write_b32 v3, v176 offset:0
    ds_write_b32 v3, v180 offset:512
    s_waitcnt lgkmcnt(6)
    v_mfma_f32_32x32x16_bf16 v[48:63], a[124:127], v[152:155], v[48:63]
    ds_write_b32 v3, v184 offset:1024
    ds_write_b32 v3, v188 offset:1536
    v_mfma_f32_32x32x16_bf16 v[64:79], a[124:127], v[156:159], v[64:79]
    s_waitcnt vmcnt(4)
    v_mov_b32 v246, s44
    v_mov_b32 v247, s45
    v_mov_b32 v248, 14614528
    s_mov_b64 exec, 1
    buffer_store_dwordx2 v[246:247], v248, s[28:31], s40 offen sc1
    s_mov_b64 exec, -1
    v_mfma_f32_4x4x4_16b_bf16 v[160:163], a[124:125], v[208:209], v[160:163]
    v_mfma_f32_4x4x4_16b_bf16 v[164:167], a[124:125], a[124:125], v[164:167]
    v_mfma_f32_4x4x4_16b_bf16 v[168:171], a[126:127], v[208:209], v[168:171]
    v_mfma_f32_4x4x4_16b_bf16 v[172:175], a[126:127], a[126:127], v[172:175]
    s_waitcnt lgkmcnt(4)
    v_mfma_f32_32x32x16_bf16 v[80:95], v[128:131], a[0:3], 0
    ds_read_b64_tr_b16 v[136:137], v213 offset:0
    ds_read_b64_tr_b16 v[138:139], v213 offset:256
    v_mfma_f32_16x16x32_bf16 v[192:195], v[204:207], v[128:131], 0
    v_mfma_f32_32x32x16_bf16 v[96:111], v[132:135], a[0:3], 0
    ds_read_b64_tr_b16 v[140:141], v213 offset:4096
    ds_read_b64_tr_b16 v[142:143], v213 offset:4352
    v_mfma_f32_16x16x32_bf16 v[196:199], v[204:207], v[132:135], 0
    v_pk_add_f32 v[160:161], v[160:161], v[168:169]
    v_pk_add_f32 v[164:165], v[164:165], v[172:173]
    v_pk_add_f32 v[162:163], v[162:163], v[170:171]
    v_pk_add_f32 v[166:167], v[166:167], v[174:175]
    s_mov_b32 s56, 0x22222222
    s_mov_b32 s57, 0x22222222
    s_mov_b32 s58, 0x44444444
    s_mov_b32 s59, 0x44444444
    s_mov_b32 s60, 0x88888888
    s_mov_b32 s61, 0x88888888
    v_cndmask_b32 v160, v160, v161, s[56:57]
    v_cndmask_b32 v164, v164, v165, s[56:57]
    v_cndmask_b32 v160, v160, v162, s[58:59]
    v_cndmask_b32 v164, v164, v166, s[58:59]
    v_cndmask_b32 v160, v160, v163, s[60:61]
    v_cndmask_b32 v164, v164, v167, s[60:61]
    v_mov_b32 v168, v160
    v_mov_b32 v172, v164
    s_waitcnt lgkmcnt(0)
    v_mfma_f32_32x32x16_bf16 v[80:95], v[136:139], a[4:7], v[80:95]
    ds_read_b64_tr_b16 v[128:129], v214 offset:0
    ds_read_b64_tr_b16 v[130:131], v214 offset:256
    s_nop 0
    s_nop 0
    v_permlane32_swap_b32 v160, v168
    v_permlane32_swap_b32 v164, v172
    s_nop 0
    v_add_f32 v160, v160, v168
    v_add_f32 v164, v164, v172
    v_mul_f32 v160, 0x3b000000, v160
    v_mul_f32 v164, 0x3b000000, v164
    v_fma_f32 v164, -v160, v160, v164
    v_max_f32 v164, 0, v164
    v_cvt_pk_bf16_f32 v160, v160, v160
    v_and_b32 v160, s69, v160
    v_cvt_pk_bf16_f32 v164, v164, v164
    v_and_b32 v164, s69, v164
    v_add_f32 v164, 0x3727c5ac, v164
    v_cvt_pk_bf16_f32 v164, v164, v164
    v_and_b32 v164, s69, v164
    v_mfma_f32_32x32x16_bf16 v[96:111], v[140:143], a[4:7], v[96:111]
    ds_read_b64_tr_b16 v[132:133], v214 offset:4096
    ds_read_b64_tr_b16 v[134:135], v214 offset:4352
    v_sqrt_f32 v164, v164
    s_nop 0
    v_cvt_pk_bf16_f32 v164, v164, v164
    v_and_b32 v164, s69, v164
    v_rcp_f32 v2, v164
    v_xor_b32 v160, 0x80000000, v160
    v_cvt_pk_bf16_f32 v8, v160, v160
    v_cndmask_b32 v8, 0, v8, s[100:101]
    v_mov_b32 v9, v8
    v_mov_b32 v10, v8
    v_mov_b32 v11, v8
    s_lshl_b32 s56, s36, 8
    v_and_b32 v232, 31, v1
    v_lshlrev_b32 v232, 2, v232
    v_add_u32 v232, s56, v232
    v_add_u32 v232, 157696, v232
    ds_write_b32 v232, v2
    s_waitcnt lgkmcnt(1)
    v_mfma_f32_32x32x16_bf16 v[80:95], v[128:131], a[8:11], v[80:95]
    s_waitcnt vmcnt(3) lgkmcnt(0)
    s_barrier
    s_add_u32 s39, s39, 0x20000000
    s_mul_hi_u32 s42, s39, 1835008
    s_add_u32 m0, s43, 49152
    ds_read_b64_tr_b16 v[136:137], v215 offset:0
    ds_read_b64_tr_b16 v[138:139], v215 offset:256
    buffer_load_dwordx4 v224, s[12:15], s42 offen lds
    v_mfma_f32_32x32x16_bf16 v[96:111], v[132:135], a[8:11], v[96:111]
    s_add_u32 m0, s43, 53248
    ds_read_b64_tr_b16 v[140:141], v215 offset:4096
    ds_read_b64_tr_b16 v[142:143], v215 offset:4352
    buffer_load_dwordx4 v225, s[12:15], s42 offen lds
    s_lshl_b32 s56, s36, 8
    v_lshrrev_b32 v246, 5, v1
    v_lshlrev_b32 v246, 4, v246
    v_add_u32 v246, s56, v246
    v_add_u32 v246, 157696, v246
    ds_read_b128 v[112:115], v246 offset:0
    ds_read_b128 v[116:119], v246 offset:32
    ds_read_b128 v[120:123], v246 offset:64
    ds_read_b128 v[124:127], v246 offset:96
    ds_read_b128 v[176:179], v6 offset:0
    ds_read_b128 v[180:183], v6 offset:512
    ds_read_b128 v[184:187], v6 offset:1024
    ds_read_b128 v[188:191], v6 offset:1536
    s_waitcnt lgkmcnt(3)
    v_mfma_f32_32x32x16_bf16 v[16:31], v[8:11], v[176:179], v[16:31]
    s_waitcnt lgkmcnt(2)
    v_mfma_f32_32x32x16_bf16 v[32:47], v[8:11], v[180:183], v[32:47]
    s_waitcnt lgkmcnt(1)
    v_mfma_f32_32x32x16_bf16 v[80:95], v[136:139], a[12:15], v[80:95]
    s_lshl_b32 s62, s70, 4
    s_add_u32 m0, s3, 0
    ds_read_b64_tr_b16 v[128:129], v212 offset:16384
    ds_read_b64_tr_b16 v[130:131], v212 offset:16640
    buffer_load_dwordx4 v254, s[16:19], s62 offen lds
    v_mfma_f32_32x32x16_bf16 v[48:63], v[8:11], v[184:187], v[48:63]
    s_waitcnt lgkmcnt(2)
    v_mfma_f32_32x32x16_bf16 v[64:79], v[8:11], v[188:191], v[64:79]
    s_nop 11
    v_mov_b32 v248, 0x3fb8aa3b
    v_pk_mul_f32 v[176:177], v[112:113], v[248:249] op_sel_hi:[1,0]
    v_pk_mul_f32 v[178:179], v[114:115], v[248:249] op_sel_hi:[1,0]
    v_pk_mul_f32 v[180:181], v[116:117], v[248:249] op_sel_hi:[1,0]
    v_pk_mul_f32 v[182:183], v[118:119], v[248:249] op_sel_hi:[1,0]
    v_pk_mul_f32 v[184:185], v[120:121], v[248:249] op_sel_hi:[1,0]
    v_pk_mul_f32 v[186:187], v[122:123], v[248:249] op_sel_hi:[1,0]
    v_pk_mul_f32 v[188:189], v[124:125], v[248:249] op_sel_hi:[1,0]
    v_pk_mul_f32 v[190:191], v[126:127], v[248:249] op_sel_hi:[1,0]
    v_pk_mul_f32 v[16:17], v[16:17], v[176:177]
    v_pk_mul_f32 v[18:19], v[18:19], v[178:179]
    v_exp_f32 v248, v16 clamp
    v_exp_f32 v249, v17 clamp
    v_mfma_f32_32x32x16_bf16 v[96:111], v[140:143], a[12:15], v[96:111]
    s_add_u32 m0, s3, 1024
    ds_read_b64_tr_b16 v[132:133], v212 offset:20480
    ds_read_b64_tr_b16 v[134:135], v212 offset:20736
    buffer_load_dwordx4 v255, s[16:19], s62 offen lds
    v_exp_f32 v250, v18 clamp
    v_exp_f32 v251, v19 clamp
    v_max_f32 v16, 0, v16
    v_max_f32 v17, 0, v17
    v_max_f32 v18, 0, v18
    v_max_f32 v19, 0, v19
    v_pk_add_f32 v[248:249], v[248:249], s[66:67] op_sel_hi:[1,0]
    v_pk_add_f32 v[250:251], v[250:251], s[66:67] op_sel_hi:[1,0]
    v_pk_fma_f32 v[16:17], v[16:17], s[68:69], v[248:249] op_sel_hi:[1,0,1]
    v_pk_fma_f32 v[18:19], v[18:19], s[68:69], v[250:251] op_sel_hi:[1,0,1]
    v_cvt_pk_bf16_f32 v144, v16, v17
    v_cvt_pk_bf16_f32 v145, v18, v19
    v_pk_mul_f32 v[20:21], v[20:21], v[180:181]
    v_pk_mul_f32 v[22:23], v[22:23], v[182:183]
    v_exp_f32 v248, v20 clamp
    v_exp_f32 v249, v21 clamp
    v_exp_f32 v250, v22 clamp
    s_waitcnt lgkmcnt(0)
    v_mfma_f32_32x32x16_bf16 v[80:95], v[128:131], a[16:19], v[80:95]
    s_lshl_b32 s62, s71, 4
    s_add_u32 m0, s3, 2048
    ds_read_b64_tr_b16 v[136:137], v213 offset:16384
    ds_read_b64_tr_b16 v[138:139], v213 offset:16640
    buffer_load_dwordx4 v254, s[16:19], s62 offen lds
    v_mfma_f32_16x16x32_bf16 v[192:195], v[204:207], v[128:131], v[192:195]
    v_exp_f32 v251, v23 clamp
    v_max_f32 v20, 0, v20
    v_max_f32 v21, 0, v21
    v_max_f32 v22, 0, v22
    v_max_f32 v23, 0, v23
    v_pk_add_f32 v[248:249], v[248:249], s[66:67] op_sel_hi:[1,0]
    v_pk_add_f32 v[250:251], v[250:251], s[66:67] op_sel_hi:[1,0]
    v_pk_fma_f32 v[20:21], v[20:21], s[68:69], v[248:249] op_sel_hi:[1,0,1]
    v_pk_fma_f32 v[22:23], v[22:23], s[68:69], v[250:251] op_sel_hi:[1,0,1]
    v_cvt_pk_bf16_f32 v146, v20, v21
    v_cvt_pk_bf16_f32 v147, v22, v23
    v_pk_mul_f32 v[24:25], v[24:25], v[184:185]
    v_pk_mul_f32 v[26:27], v[26:27], v[186:187]
    v_exp_f32 v248, v24 clamp
    v_exp_f32 v249, v25 clamp
    v_exp_f32 v250, v26 clamp
    v_exp_f32 v251, v27 clamp
    v_max_f32 v24, 0, v24
    v_mfma_f32_32x32x16_bf16 v[96:111], v[132:135], a[16:19], v[96:111]
    s_add_u32 m0, s3, 3072
    ds_read_b64_tr_b16 v[140:141], v213 offset:20480
    ds_read_b64_tr_b16 v[142:143], v213 offset:20736
    buffer_load_dwordx4 v255, s[16:19], s62 offen lds
    v_mfma_f32_16x16x32_bf16 v[196:199], v[204:207], v[132:135], v[196:199]
    v_max_f32 v25, 0, v25
    v_max_f32 v26, 0, v26
    v_max_f32 v27, 0, v27
    v_pk_add_f32 v[248:249], v[248:249], s[66:67] op_sel_hi:[1,0]
    v_pk_add_f32 v[250:251], v[250:251], s[66:67] op_sel_hi:[1,0]
    v_pk_fma_f32 v[24:25], v[24:25], s[68:69], v[248:249] op_sel_hi:[1,0,1]
    v_pk_fma_f32 v[26:27], v[26:27], s[68:69], v[250:251] op_sel_hi:[1,0,1]
    v_cvt_pk_bf16_f32 v148, v24, v25
    v_cvt_pk_bf16_f32 v149, v26, v27
    v_pk_mul_f32 v[28:29], v[28:29], v[188:189]
    v_pk_mul_f32 v[30:31], v[30:31], v[190:191]
    v_exp_f32 v248, v28 clamp
    v_exp_f32 v249, v29 clamp
    v_exp_f32 v250, v30 clamp
    v_exp_f32 v251, v31 clamp
    v_max_f32 v28, 0, v28
    v_max_f32 v29, 0, v29
    s_waitcnt lgkmcnt(0)
    v_mfma_f32_32x32x16_bf16 v[80:95], v[136:139], a[20:23], v[80:95]
    s_lshl_b32 s62, s72, 4
    s_add_u32 m0, s3, 4096
    ds_read_b64_tr_b16 v[128:129], v214 offset:16384
    ds_read_b64_tr_b16 v[130:131], v214 offset:16640
    buffer_load_dwordx4 v254, s[16:19], s62 offen lds
    v_max_f32 v30, 0, v30
    v_max_f32 v31, 0, v31
    v_pk_add_f32 v[248:249], v[248:249], s[66:67] op_sel_hi:[1,0]
    v_pk_add_f32 v[250:251], v[250:251], s[66:67] op_sel_hi:[1,0]
    v_pk_fma_f32 v[28:29], v[28:29], s[68:69], v[248:249] op_sel_hi:[1,0,1]
    v_pk_fma_f32 v[30:31], v[30:31], s[68:69], v[250:251] op_sel_hi:[1,0,1]
    v_cvt_pk_bf16_f32 v150, v28, v29
    v_cvt_pk_bf16_f32 v151, v30, v31
    v_pk_mul_f32 v[32:33], v[32:33], v[176:177]
    v_pk_mul_f32 v[34:35], v[34:35], v[178:179]
    v_exp_f32 v248, v32 clamp
    v_exp_f32 v249, v33 clamp
    v_exp_f32 v250, v34 clamp
    v_exp_f32 v251, v35 clamp
    v_max_f32 v32, 0, v32
    v_max_f32 v33, 0, v33
    v_max_f32 v34, 0, v34
    v_max_f32 v35, 0, v35
    v_mfma_f32_32x32x16_bf16 v[96:111], v[140:143], a[20:23], v[96:111]
    s_add_u32 m0, s3, 5120
    ds_read_b64_tr_b16 v[132:133], v214 offset:20480
    ds_read_b64_tr_b16 v[134:135], v214 offset:20736
    buffer_load_dwordx4 v255, s[16:19], s62 offen lds
    v_pk_add_f32 v[248:249], v[248:249], s[66:67] op_sel_hi:[1,0]
    v_pk_add_f32 v[250:251], v[250:251], s[66:67] op_sel_hi:[1,0]
    v_pk_fma_f32 v[32:33], v[32:33], s[68:69], v[248:249] op_sel_hi:[1,0,1]
    v_pk_fma_f32 v[34:35], v[34:35], s[68:69], v[250:251] op_sel_hi:[1,0,1]
    v_cvt_pk_bf16_f32 v152, v32, v33
    v_cvt_pk_bf16_f32 v153, v34, v35
    v_pk_mul_f32 v[36:37], v[36:37], v[180:181]
    v_pk_mul_f32 v[38:39], v[38:39], v[182:183]
    v_exp_f32 v248, v36 clamp
    v_exp_f32 v249, v37 clamp
    v_exp_f32 v250, v38 clamp
    v_exp_f32 v251, v39 clamp
    v_max_f32 v36, 0, v36
    v_max_f32 v37, 0, v37
    v_max_f32 v38, 0, v38
    v_max_f32 v39, 0, v39
    v_pk_add_f32 v[248:249], v[248:249], s[66:67] op_sel_hi:[1,0]
    s_waitcnt lgkmcnt(0)
    v_mfma_f32_32x32x16_bf16 v[80:95], v[128:131], a[24:27], v[80:95]
    s_waitcnt vmcnt(9)
    s_barrier
    s_add_u32 s39, s39, 0x20000000
    s_mul_hi_u32 s42, s39, 1835008
    s_add_u32 m0, s43, 0
    ds_read_b64_tr_b16 v[136:137], v215 offset:16384
    ds_read_b64_tr_b16 v[138:139], v215 offset:16640
    buffer_load_dwordx4 v224, s[12:15], s42 offen lds
    v_pk_add_f32 v[250:251], v[250:251], s[66:67] op_sel_hi:[1,0]
    v_pk_fma_f32 v[36:37], v[36:37], s[68:69], v[248:249] op_sel_hi:[1,0,1]
    v_pk_fma_f32 v[38:39], v[38:39], s[68:69], v[250:251] op_sel_hi:[1,0,1]
    v_cvt_pk_bf16_f32 v154, v36, v37
    v_cvt_pk_bf16_f32 v155, v38, v39
    v_pk_mul_f32 v[40:41], v[40:41], v[184:185]
    v_pk_mul_f32 v[42:43], v[42:43], v[186:187]
    v_exp_f32 v248, v40 clamp
    v_exp_f32 v249, v41 clamp
    v_exp_f32 v250, v42 clamp
    v_exp_f32 v251, v43 clamp
    v_max_f32 v40, 0, v40
    v_max_f32 v41, 0, v41
    v_max_f32 v42, 0, v42
    v_max_f32 v43, 0, v43
    v_pk_add_f32 v[248:249], v[248:249], s[66:67] op_sel_hi:[1,0]
    v_pk_add_f32 v[250:251], v[250:251], s[66:67] op_sel_hi:[1,0]
    v_pk_fma_f32 v[40:41], v[40:41], s[68:69], v[248:249] op_sel_hi:[1,0,1]
    v_mfma_f32_32x32x16_bf16 v[96:111], v[132:135], a[24:27], v[96:111]
    s_add_u32 m0, s43, 4096
    ds_read_b64_tr_b16 v[140:141], v215 offset:20480
    ds_read_b64_tr_b16 v[142:143], v215 offset:20736
    buffer_load_dwordx4 v225, s[12:15], s42 offen lds
    v_pk_fma_f32 v[42:43], v[42:43], s[68:69], v[250:251] op_sel_hi:[1,0,1]
    v_cvt_pk_bf16_f32 v156, v40, v41
    v_cvt_pk_bf16_f32 v157, v42, v43
    v_pk_mul_f32 v[44:45], v[44:45], v[188:189]
    v_pk_mul_f32 v[46:47], v[46:47], v[190:191]
    v_exp_f32 v248, v44 clamp
    v_exp_f32 v249, v45 clamp
    v_exp_f32 v250, v46 clamp
    v_exp_f32 v251, v47 clamp
    v_max_f32 v44, 0, v44
    v_max_f32 v45, 0, v45
    v_max_f32 v46, 0, v46
    v_max_f32 v47, 0, v47
    v_pk_add_f32 v[248:249], v[248:249], s[66:67] op_sel_hi:[1,0]
    v_pk_add_f32 v[250:251], v[250:251], s[66:67] op_sel_hi:[1,0]
    v_pk_fma_f32 v[44:45], v[44:45], s[68:69], v[248:249] op_sel_hi:[1,0,1]
    v_pk_fma_f32 v[46:47], v[46:47], s[68:69], v[250:251] op_sel_hi:[1,0,1]
    v_cvt_pk_bf16_f32 v158, v44, v45
    s_waitcnt lgkmcnt(0)
    v_mfma_f32_32x32x16_bf16 v[80:95], v[136:139], a[28:31], v[80:95]
    s_lshl_b32 s62, s73, 4
    s_add_u32 m0, s3, 6144
    ds_read_b64_tr_b16 v[128:129], v212 offset:32768
    ds_read_b64_tr_b16 v[130:131], v212 offset:33024
    buffer_load_dwordx4 v254, s[16:19], s62 offen lds
    v_cvt_pk_bf16_f32 v159, v46, v47
    v_pk_mul_f32 v[48:49], v[48:49], v[112:113]
    v_pk_mul_f32 v[50:51], v[50:51], v[114:115]
    v_cvt_pk_bf16_f32 v160, v48, v49
    v_cvt_pk_bf16_f32 v161, v50, v51
    v_pk_mul_f32 v[52:53], v[52:53], v[116:117]
    v_pk_mul_f32 v[54:55], v[54:55], v[118:119]
    v_cvt_pk_bf16_f32 v162, v52, v53
    v_cvt_pk_bf16_f32 v163, v54, v55
    v_pk_mul_f32 v[56:57], v[56:57], v[120:121]
    v_pk_mul_f32 v[58:59], v[58:59], v[122:123]
    v_cvt_pk_bf16_f32 v164, v56, v57
    v_cvt_pk_bf16_f32 v165, v58, v59
    v_pk_mul_f32 v[60:61], v[60:61], v[124:125]
    v_pk_mul_f32 v[62:63], v[62:63], v[126:127]
    v_cvt_pk_bf16_f32 v166, v60, v61
    v_cvt_pk_bf16_f32 v167, v62, v63
    v_mfma_f32_32x32x16_bf16 v[96:111], v[140:143], a[28:31], v[96:111]
    s_add_u32 m0, s3, 7168
    ds_read_b64_tr_b16 v[132:133], v212 offset:36864
    ds_read_b64_tr_b16 v[134:135], v212 offset:37120
    buffer_load_dwordx4 v255, s[16:19], s62 offen lds
    v_pk_mul_f32 v[64:65], v[64:65], v[112:113]
    v_pk_mul_f32 v[66:67], v[66:67], v[114:115]
    v_cvt_pk_bf16_f32 v168, v64, v65
    v_cvt_pk_bf16_f32 v169, v66, v67
    v_pk_mul_f32 v[68:69], v[68:69], v[116:117]
    v_pk_mul_f32 v[70:71], v[70:71], v[118:119]
    v_cvt_pk_bf16_f32 v170, v68, v69
    v_cvt_pk_bf16_f32 v171, v70, v71
    v_pk_mul_f32 v[72:73], v[72:73], v[120:121]
    v_pk_mul_f32 v[74:75], v[74:75], v[122:123]
    v_cvt_pk_bf16_f32 v172, v72, v73
    v_cvt_pk_bf16_f32 v173, v74, v75
    v_pk_mul_f32 v[76:77], v[76:77], v[124:125]
    v_pk_mul_f32 v[78:79], v[78:79], v[126:127]
    v_cvt_pk_bf16_f32 v174, v76, v77
    v_cvt_pk_bf16_f32 v175, v78, v79
    s_nop 1
    v_mfma_f32_32x32x16_bf16 v[16:31], v[144:147], v[160:163], 0
    s_waitcnt lgkmcnt(0)
    v_mfma_f32_32x32x16_bf16 v[80:95], v[128:131], a[32:35], v[80:95]
    s_lshl_b32 s62, s74, 4
    s_add_u32 m0, s3, 8192
    ds_read_b64_tr_b16 v[136:137], v213 offset:32768
    ds_read_b64_tr_b16 v[138:139], v213 offset:33024
    buffer_load_dwordx4 v254, s[16:19], s62 offen lds
    v_mfma_f32_16x16x32_bf16 v[192:195], v[204:207], v[128:131], v[192:195]
    v_bfe_u32 v232, v1, 1, 4
    v_lshlrev_b32 v232, 7, v232
    v_mfma_f32_32x32x16_bf16 v[32:47], v[144:147], v[208:211], 0
    v_mfma_f32_32x32x16_bf16 v[48:63], v[152:155], v[168:171], 0
    v_mfma_f32_32x32x16_bf16 v[64:79], v[152:155], v[208:211], 0
    v_mfma_f32_32x32x16_bf16 v[16:31], v[148:151], v[164:167], v[16:31]
    v_mfma_f32_32x32x16_bf16 v[32:47], v[148:151], v[208:211], v[32:47]
    v_mfma_f32_32x32x16_bf16 v[48:63], v[156:159], v[172:175], v[48:63]
    v_mfma_f32_32x32x16_bf16 v[64:79], v[156:159], v[208:211], v[64:79]
    s_lshl_b32 s56, s36, 13
    v_lshlrev_b32 v246, 4, v1
    v_add_u32 v246, s56, v246
    v_add_u32 v246, 65536, v246
    s_nop 11
    v_cndmask_b32 v16, v32, v16, s[54:55]
    v_cndmask_b32 v17, v33, v17, s[54:55]
    v_cndmask_b32 v18, v34, v18, s[54:55]
    v_cndmask_b32 v19, v35, v19, s[54:55]
    ds_write_b128 v246, v[16:19] offset:0
    s_waitcnt vmcnt(5)
    ds_read_b64_tr_b16 a[128:129], v12 offset:0
    ds_read_b64_tr_b16 a[130:131], v12 offset:512
    ds_read_b64_tr_b16 a[132:133], v12 offset:1024
    v_mfma_f32_32x32x16_bf16 v[96:111], v[132:135], a[32:35], v[96:111]
    s_add_u32 m0, s3, 9216
    ds_read_b64_tr_b16 v[140:141], v213 offset:36864
    ds_read_b64_tr_b16 v[142:143], v213 offset:37120
    buffer_load_dwordx4 v255, s[16:19], s62 offen lds
    v_mfma_f32_16x16x32_bf16 v[196:199], v[204:207], v[132:135], v[196:199]
    v_and_b32 v228, 1, v1
    v_lshl_add_u32 v232, v228, 4, v232
    v_cndmask_b32 v20, v36, v20, s[54:55]
    v_cndmask_b32 v21, v37, v21, s[54:55]
    v_cndmask_b32 v22, v38, v22, s[54:55]
    v_cndmask_b32 v23, v39, v23, s[54:55]
    ds_write_b128 v246, v[20:23] offset:1024
    v_cndmask_b32 v24, v24, v40, s[54:55]
    v_cndmask_b32 v25, v25, v41, s[54:55]
    v_cndmask_b32 v26, v26, v42, s[54:55]
    v_cndmask_b32 v27, v27, v43, s[54:55]
    ds_write_b128 v246, v[24:27] offset:2048
    v_cndmask_b32 v28, v28, v44, s[54:55]
    v_cndmask_b32 v29, v29, v45, s[54:55]
    v_cndmask_b32 v30, v30, v46, s[54:55]
    v_cndmask_b32 v31, v31, v47, s[54:55]
    ds_write_b128 v246, v[28:31] offset:3072
    v_cndmask_b32 v48, v64, v48, s[54:55]
    v_cndmask_b32 v49, v65, v49, s[54:55]
    v_cndmask_b32 v50, v66, v50, s[54:55]
    ds_read_b64_tr_b16 a[134:135], v12 offset:1536
    ds_read_b64_tr_b16 a[136:137], v12 offset:2048
    ds_read_b64_tr_b16 a[138:139], v12 offset:2560
    s_waitcnt lgkmcnt(6)
    v_mfma_f32_32x32x16_bf16 v[80:95], v[136:139], a[36:39], v[80:95]
    s_lshl_b32 s62, s75, 4
    s_add_u32 m0, s3, 10240
    ds_read_b64_tr_b16 v[128:129], v214 offset:32768
    ds_read_b64_tr_b16 v[130:131], v214 offset:33024
    buffer_load_dwordx4 v254, s[16:19], s62 offen lds
    s_lshl_b32 s57, s38, 11
    s_add_u32 s57, s57, 14811136
    v_cndmask_b32 v51, v67, v51, s[54:55]
    ds_write_b128 v246, v[48:51] offset:4096
    v_cndmask_b32 v52, v68, v52, s[54:55]
    v_cndmask_b32 v53, v69, v53, s[54:55]
    v_cndmask_b32 v54, v70, v54, s[54:55]
    v_cndmask_b32 v55, v71, v55, s[54:55]
    ds_write_b128 v246, v[52:55] offset:5120
    v_cndmask_b32 v56, v56, v72, s[54:55]
    v_cndmask_b32 v57, v57, v73, s[54:55]
    v_cndmask_b32 v58, v58, v74, s[54:55]
    v_cndmask_b32 v59, v59, v75, s[54:55]
    ds_write_b128 v246, v[56:59] offset:6144
    v_cndmask_b32 v60, v60, v76, s[54:55]
    v_cndmask_b32 v61, v61, v77, s[54:55]
    v_cndmask_b32 v62, v62, v78, s[54:55]
    v_cndmask_b32 v63, v63, v79, s[54:55]
    ds_write_b128 v246, v[60:63] offset:7168
    ds_read_b64_tr_b16 a[140:141], v12 offset:3072
    ds_read_b64_tr_b16 a[142:143], v12 offset:3584
    ds_read_b64_tr_b16 a[144:145], v12 offset:4096
    v_mfma_f32_32x32x16_bf16 v[96:111], v[140:143], a[36:39], v[96:111]
    s_add_u32 m0, s3, 11264
    ds_read_b64_tr_b16 v[132:133], v214 offset:36864
    ds_read_b64_tr_b16 v[134:135], v214 offset:37120
    buffer_load_dwordx4 v255, s[16:19], s62 offen lds
    v_add_u32 v232, s57, v232
    buffer_load_dwordx4 v[228:231], v232, s[28:31], 0 offen sc1
    ds_read_b64_tr_b16 a[146:147], v12 offset:4608
    ds_read_b64_tr_b16 a[148:149], v12 offset:5120
    ds_read_b64_tr_b16 a[150:151], v12 offset:5632
    s_waitcnt lgkmcnt(3)
    v_mfma_f32_32x32x16_bf16 v[80:95], v[128:131], a[40:43], v[80:95]
    s_barrier
    s_add_u32 s39, s39, 0x20000000
    s_mul_hi_u32 s42, s39, 1835008
    s_add_u32 m0, s43, 16384
    ds_read_b64_tr_b16 v[136:137], v215 offset:32768
    ds_read_b64_tr_b16 v[138:139], v215 offset:33024
    buffer_load_dwordx4 v224, s[12:15], s42 offen lds
    v_mfma_f32_32x32x16_bf16 v[96:111], v[132:135], a[40:43], v[96:111]
    s_add_u32 m0, s43, 20480
    ds_read_b64_tr_b16 v[140:141], v215 offset:36864
    ds_read_b64_tr_b16 v[142:143], v215 offset:37120
    buffer_load_dwordx4 v225, s[12:15], s42 offen lds
    v_lshlrev_b32 v246, 2, v0
    v_add_u32 v247, 65536, v246
    ds_read2st64_b32 v[16:17], v247 offset0:0 offset1:4
    ds_read2st64_b32 v[18:19], v247 offset0:32 offset1:36
    ds_read2st64_b32 v[20:21], v247 offset0:64 offset1:68
    ds_read2st64_b32 v[22:23], v247 offset0:96 offset1:100
    ds_read2st64_b32 v[24:25], v247 offset0:8 offset1:12
    s_waitcnt lgkmcnt(5)
    v_mfma_f32_32x32x16_bf16 v[80:95], v[136:139], a[44:47], v[80:95]
    s_lshl_b32 s62, s36, 17
    s_add_u32 m0, s3, 0
    ds_read_b64_tr_b16 v[128:129], v212 offset:49152
    ds_read_b64_tr_b16 v[130:131], v212 offset:49408
    buffer_load_dwordx4 v254, s[20:23], s62 offen lds
    ds_read2st64_b32 v[26:27], v247 offset0:40 offset1:44
    ds_read2st64_b32 v[28:29], v247 offset0:72 offset1:76
    ds_read2st64_b32 v[30:31], v247 offset0:104 offset1:108
    ds_read2st64_b32 v[32:33], v247 offset0:16 offset1:20
    ds_read2st64_b32 v[34:35], v247 offset0:48 offset1:52
    ds_read2st64_b32 v[36:37], v247 offset0:80 offset1:84
    ds_read2st64_b32 v[38:39], v247 offset0:112 offset1:116
    v_mfma_f32_32x32x16_bf16 v[96:111], v[140:143], a[44:47], v[96:111]
    s_add_u32 m0, s3, 1024
    ds_read_b64_tr_b16 v[132:133], v212 offset:53248
    ds_read_b64_tr_b16 v[134:135], v212 offset:53504
    buffer_load_dwordx4 v255, s[20:23], s62 offen lds
    ds_read2st64_b32 v[40:41], v247 offset0:24 offset1:28
    ds_read2st64_b32 v[42:43], v247 offset0:56 offset1:60
    ds_read2st64_b32 v[44:45], v247 offset0:88 offset1:92
    ds_read2st64_b32 v[46:47], v247 offset0:120 offset1:124
    s_lshl_b32 s57, s38, 13
    v_add_u32 v246, 13631488, v246
    s_waitcnt lgkmcnt(4)
    v_mfma_f32_32x32x16_bf16 v[80:95], v[128:131], a[48:51], v[80:95]
    s_lshl_b32 s62, s76, 4
    s_add_u32 m0, s3, 2048
    ds_read_b64_tr_b16 v[136:137], v213 offset:49152
    ds_read_b64_tr_b16 v[138:139], v213 offset:49408
    buffer_load_dwordx4 v254, s[16:19], s62 offen lds
    v_mfma_f32_16x16x32_bf16 v[192:195], v[204:207], v[128:131], v[192:195]
    v_add_u32 v247, 4096, v246
    s_waitcnt vmcnt(5)
    s_mov_b32 s67, 0x8000
c2p_5:
    v_cmp_ne_u64 vcc, s[44:45], v[228:229]
    v_cmp_ne_u64 s[60:61], s[44:45], v[230:231]
    s_or_b64 vcc, vcc, s[60:61]
    s_cbranch_vccz c2ok_4
    buffer_load_dwordx4 v[228:231], v232, s[28:31], 0 offen sc1
    s_waitcnt vmcnt(0)
    s_sub_u32 s67, s67, 1
    s_cmp_lg_u32 s67, 0
    s_cbranch_scc1 c2p_5
c2ok_4:
    v_pk_add_f32 v[16:17], v[16:17], v[18:19]
    v_pk_add_f32 v[20:21], v[20:21], v[22:23]
    v_pk_add_f32 v[16:17], v[16:17], v[20:21]
    buffer_atomic_add_f32 v16, v246, s[28:31], s57 offen offset:0 sc1
    ds_read_b64_tr_b16 a[152:153], v12 offset:6144
    ds_read_b64_tr_b16 a[154:155], v12 offset:6656
    ds_read_b64_tr_b16 a[156:157], v12 offset:7168
    v_mfma_f32_32x32x16_bf16 v[96:111], v[132:135], a[48:51], v[96:111]
    s_add_u32 m0, s3, 3072
    ds_read_b64_tr_b16 v[140:141], v213 offset:53248
    ds_read_b64_tr_b16 v[142:143], v213 offset:53504
    buffer_load_dwordx4 v255, s[16:19], s62 offen lds
    v_mfma_f32_16x16x32_bf16 v[196:199], v[204:207], v[132:135], v[196:199]
    buffer_atomic_add_f32 v17, v246, s[28:31], s57 offen offset:1024 sc1
    v_pk_add_f32 v[24:25], v[24:25], v[26:27]
    v_pk_add_f32 v[28:29], v[28:29], v[30:31]
    v_pk_add_f32 v[24:25], v[24:25], v[28:29]
    buffer_atomic_add_f32 v24, v246, s[28:31], s57 offen offset:2048 sc1
    ds_read_b64_tr_b16 a[158:159], v12 offset:7680
    ds_read_b64_tr_b16 a[160:161], v12 offset:8192
    ds_read_b64_tr_b16 a[162:163], v12 offset:8704
    s_waitcnt lgkmcnt(3)
    v_mfma_f32_32x32x16_bf16 v[80:95], v[136:139], a[52:55], v[80:95]
    s_lshl_b32 s62, s36, 17
    s_add_u32 s62, s62, 16384
    s_add_u32 m0, s3, 4096
    ds_read_b64_tr_b16 v[128:129], v214 offset:49152
    ds_read_b64_tr_b16 v[130:131], v214 offset:49408
    buffer_load_dwordx4 v254, s[20:23], s62 offen lds
    buffer_atomic_add_f32 v25, v246, s[28:31], s57 offen offset:3072 sc1
    v_pk_add_f32 v[32:33], v[32:33], v[34:35]
    v_pk_add_f32 v[36:37], v[36:37], v[38:39]
    v_pk_add_f32 v[32:33], v[32:33], v[36:37]
    buffer_atomic_add_f32 v32, v247, s[28:31], s57 offen offset:0 sc1
    buffer_atomic_add_f32 v33, v247, s[28:31], s57 offen offset:1024 sc1
    ds_read_b64_tr_b16 a[164:165], v12 offset:9216
    ds_read_b64_tr_b16 a[166:167], v12 offset:9728
    ds_read_b64_tr_b16 a[168:169], v12 offset:10240
    v_mfma_f32_32x32x16_bf16 v[96:111], v[140:143], a[52:55], v[96:111]
    s_add_u32 m0, s3, 5120
    ds_read_b64_tr_b16 v[132:133], v214 offset:53248
    ds_read_b64_tr_b16 v[134:135], v214 offset:53504
    buffer_load_dwordx4 v255, s[20:23], s62 offen lds
    v_pk_add_f32 v[40:41], v[40:41], v[42:43]
    v_pk_add_f32 v[44:45], v[44:45], v[46:47]
    v_pk_add_f32 v[40:41], v[40:41], v[44:45]
    buffer_atomic_add_f32 v40, v247, s[28:31], s57 offen offset:2048 sc1
    buffer_atomic_add_f32 v41, v247, s[28:31], s57 offen offset:3072 sc1
    ds_read_b64_tr_b16 a[170:171], v12 offset:10752
    ds_read_b64_tr_b16 a[172:173], v12 offset:11264
    ds_read_b64_tr_b16 a[174:175], v12 offset:11776
    s_waitcnt lgkmcnt(3)
    v_mfma_f32_32x32x16_bf16 v[80:95], v[128:131], a[56:59], v[80:95]
    s_barrier
    s_add_u32 s39, s39, 0x20000000
    s_mul_hi_u32 s42, s39, 1835008
    s_add_u32 m0, s43, 32768
    ds_read_b64_tr_b16 v[136:137], v215 offset:49152
    ds_read_b64_tr_b16 v[138:139], v215 offset:49408
    buffer_load_dwordx4 v224, s[12:15], s42 offen lds
    v_mfma_f32_32x32x16_bf16 v[96:111], v[132:135], a[56:59], v[96:111]
    s_add_u32 m0, s43, 36864
    ds_read_b64_tr_b16 v[140:141], v215 offset:53248
    ds_read_b64_tr_b16 v[142:143], v215 offset:53504
    buffer_load_dwordx4 v225, s[12:15], s42 offen lds
    s_waitcnt lgkmcnt(0)
    v_mfma_f32_32x32x16_bf16 v[80:95], v[136:139], a[60:63], v[80:95]
    s_lshl_b32 s62, s77, 4
    s_add_u32 m0, s3, 6144
    ds_read_b64_tr_b16 v[128:129], v212 offset:0
    ds_read_b64_tr_b16 v[130:131], v212 offset:256
    buffer_load_dwordx4 v254, s[16:19], s62 offen lds
    v_mfma_f32_32x32x16_bf16 v[96:111], v[140:143], a[60:63], v[96:111]
    s_add_u32 m0, s3, 7168
    ds_read_b64_tr_b16 v[132:133], v212 offset:4096
    ds_read_b64_tr_b16 v[134:135], v212 offset:4352
    buffer_load_dwordx4 v255, s[16:19], s62 offen lds
    s_waitcnt lgkmcnt(0)
    v_mfma_f32_32x32x16_bf16 v[80:95], v[128:131], a[64:67], v[80:95]
    s_lshl_b32 s62, s36, 17
    s_add_u32 s62, s62, 32768
    s_add_u32 m0, s3, 8192
    ds_read_b64_tr_b16 v[136:137], v213 offset:0
    ds_read_b64_tr_b16 v[138:139], v213 offset:256
    buffer_load_dwordx4 v254, s[20:23], s62 offen lds
    v_mfma_f32_16x16x32_bf16 v[192:195], v[204:207], v[128:131], v[192:195]
    s_waitcnt vmcnt(7)
    ds_read_b64_tr_b16 a[176:177], v12 offset:0
    ds_read_b64_tr_b16 a[178:179], v12 offset:512
    ds_read_b64_tr_b16 a[180:181], v12 offset:1024
    v_mfma_f32_32x32x16_bf16 v[96:111], v[132:135], a[64:67], v[96:111]
    s_add_u32 m0, s3, 9216
    ds_read_b64_tr_b16 v[140:141], v213 offset:4096
    ds_read_b64_tr_b16 v[142:143], v213 offset:4352
    buffer_load_dwordx4 v255, s[20:23], s62 offen lds
    v_mfma_f32_16x16x32_bf16 v[196:199], v[204:207], v[132:135], v[196:199]
    ds_read_b64_tr_b16 a[182:183], v12 offset:1536
    ds_read_b64_tr_b16 a[184:185], v12 offset:2048
    ds_read_b64_tr_b16 a[186:187], v12 offset:2560
    s_waitcnt lgkmcnt(3)
    v_mfma_f32_32x32x16_bf16 v[80:95], v[136:139], a[68:71], v[80:95]
    s_lshl_b32 s62, s78, 4
    s_add_u32 m0, s3, 10240
    ds_read_b64_tr_b16 v[128:129], v214 offset:0
    ds_read_b64_tr_b16 v[130:131], v214 offset:256
    buffer_load_dwordx4 v254, s[16:19], s62 offen lds
    ds_read_b64_tr_b16 a[188:189], v12 offset:3072
    ds_read_b64_tr_b16 a[190:191], v12 offset:3584
    ds_read_b64_tr_b16 a[192:193], v12 offset:4096
    v_mfma_f32_32x32x16_bf16 v[96:111], v[140:143], a[68:71], v[96:111]
    s_add_u32 m0, s3, 11264
    ds_read_b64_tr_b16 v[132:133], v214 offset:4096
    ds_read_b64_tr_b16 v[134:135], v214 offset:4352
    buffer_load_dwordx4 v255, s[16:19], s62 offen lds
    ds_read_b64_tr_b16 a[194:195], v12 offset:4608
    ds_read_b64_tr_b16 a[196:197], v12 offset:5120
    ds_read_b64_tr_b16 a[198:199], v12 offset:5632
    s_waitcnt lgkmcnt(3)
    v_mfma_f32_32x32x16_bf16 v[80:95], v[128:131], a[72:75], v[80:95]
    s_waitcnt vmcnt(8)
    s_barrier
    s_lshl_b32 s56, s38, 2
    s_add_u32 s56, s56, s36
    s_lshl_b32 s56, s56, 10
    v_lshlrev_b32 v244, 7, v1
    v_add_u32 v244, 14876672, v244
    v_mov_b32 v246, 1
    v_mov_b32 v247, 0
    s_mov_b64 exec, 0xff
    buffer_atomic_add_x2 v[246:247], v244, s[28:31], s56 offen sc1
    s_mov_b64 exec, -1
    s_add_u32 s39, s39, 0x20000000
    s_mul_hi_u32 s42, s39, 1835008
    s_add_u32 m0, s43, 49152
    ds_read_b64_tr_b16 v[136:137], v215 offset:0
    ds_read_b64_tr_b16 v[138:139], v215 offset:256
    buffer_load_dwordx4 v224, s[12:15], s42 offen lds
    v_mfma_f32_32x32x16_bf16 v[96:111], v[132:135], a[72:75], v[96:111]
    s_add_u32 m0, s43, 53248
    ds_read_b64_tr_b16 v[140:141], v215 offset:4096
    ds_read_b64_tr_b16 v[142:143], v215 offset:4352
    buffer_load_dwordx4 v225, s[12:15], s42 offen lds
    s_waitcnt lgkmcnt(0)
    v_mfma_f32_32x32x16_bf16 v[80:95], v[136:139], a[76:79], v[80:95]
    s_lshl_b32 s62, s36, 17
    s_add_u32 s62, s62, 49152
    s_add_u32 m0, s3, 0
    ds_read_b64_tr_b16 v[128:129], v212 offset:16384
    ds_read_b64_tr_b16 v[130:131], v212 offset:16640
    buffer_load_dwordx4 v254, s[20:23], s62 offen lds
    v_mfma_f32_32x32x16_bf16 v[96:111], v[140:143], a[76:79], v[96:111]
    s_add_u32 m0, s3, 1024
    ds_read_b64_tr_b16 v[132:133], v212 offset:20480
    ds_read_b64_tr_b16 v[134:135], v212 offset:20736
    buffer_load_dwordx4 v255, s[20:23], s62 offen lds
    s_waitcnt lgkmcnt(0)
    v_mfma_f32_32x32x16_bf16 v[80:95], v[128:131], a[80:83], v[80:95]
    s_lshl_b32 s62, s79, 4
    s_add_u32 m0, s3, 2048
    ds_read_b64_tr_b16 v[136:137], v213 offset:16384
    ds_read_b64_tr_b16 v[138:139], v213 offset:16640
    buffer_load_dwordx4 v254, s[16:19], s62 offen lds
    v_mfma_f32_16x16x32_bf16 v[192:195], v[204:207], v[128:131], v[192:195]
    s_waitcnt vmcnt(6)
    ds_read_b64_tr_b16 a[200:201], v12 offset:6144
    ds_read_b64_tr_b16 a[202:203], v12 offset:6656
    ds_read_b64_tr_b16 a[204:205], v12 offset:7168
    v_mfma_f32_32x32x16_bf16 v[96:111], v[132:135], a[80:83], v[96:111]
    s_add_u32 m0, s3, 3072
    ds_read_b64_tr_b16 v[140:141], v213 offset:20480
    ds_read_b64_tr_b16 v[142:143], v213 offset:20736
    buffer_load_dwordx4 v255, s[16:19], s62 offen lds
    v_mfma_f32_16x16x32_bf16 v[196:199], v[204:207], v[132:135], v[196:199]
    ds_read_b64_tr_b16 a[206:207], v12 offset:7680
    ds_read_b64_tr_b16 a[208:209], v12 offset:8192
    ds_read_b64_tr_b16 a[210:211], v12 offset:8704
    s_waitcnt lgkmcnt(3)
    v_mfma_f32_32x32x16_bf16 v[80:95], v[136:139], a[84:87], v[80:95]
    s_lshl_b32 s62, s36, 17
    s_add_u32 s62, s62, 65536
    s_add_u32 m0, s3, 4096
    ds_read_b64_tr_b16 v[128:129], v214 offset:16384
    ds_read_b64_tr_b16 v[130:131], v214 offset:16640
    buffer_load_dwordx4 v254, s[20:23], s62 offen lds
    ds_read_b64_tr_b16 a[212:213], v12 offset:9216
    ds_read_b64_tr_b16 a[214:215], v12 offset:9728
    ds_read_b64_tr_b16 a[216:217], v12 offset:10240
    v_mfma_f32_32x32x16_bf16 v[96:111], v[140:143], a[84:87], v[96:111]
    s_add_u32 m0, s3, 5120
    ds_read_b64_tr_b16 v[132:133], v214 offset:20480
    ds_read_b64_tr_b16 v[134:135], v214 offset:20736
    buffer_load_dwordx4 v255, s[20:23], s62 offen lds
    ds_read_b64_tr_b16 a[218:219], v12 offset:10752
    ds_read_b64_tr_b16 a[220:221], v12 offset:11264
    ds_read_b64_tr_b16 a[222:223], v12 offset:11776
    s_waitcnt lgkmcnt(3)
    v_mfma_f32_32x32x16_bf16 v[80:95], v[128:131], a[88:91], v[80:95]
    s_barrier
    s_lshl_b32 s62, s80, 4
    s_add_u32 m0, s3, 6144
    ds_read_b64_tr_b16 v[136:137], v215 offset:16384
    ds_read_b64_tr_b16 v[138:139], v215 offset:16640
    buffer_load_dwordx4 v254, s[16:19], s62 offen lds
    v_mfma_f32_32x32x16_bf16 v[96:111], v[132:135], a[88:91], v[96:111]
    s_add_u32 m0, s3, 7168
    ds_read_b64_tr_b16 v[140:141], v215 offset:20480
    ds_read_b64_tr_b16 v[142:143], v215 offset:20736
    buffer_load_dwordx4 v255, s[16:19], s62 offen lds
    s_waitcnt lgkmcnt(0)
    v_mfma_f32_32x32x16_bf16 v[80:95], v[136:139], a[92:95], v[80:95]
    s_lshl_b32 s62, s36, 17
    s_add_u32 s62, s62, 81920
    s_add_u32 m0, s3, 8192
    ds_read_b64_tr_b16 v[128:129], v212 offset:32768
    ds_read_b64_tr_b16 v[130:131], v212 offset:33024
    buffer_load_dwordx4 v254, s[20:23], s62 offen lds
    v_mfma_f32_32x32x16_bf16 v[96:111], v[140:143], a[92:95], v[96:111]
    s_add_u32 m0, s3, 9216
    ds_read_b64_tr_b16 v[132:133], v212 offset:36864
    ds_read_b64_tr_b16 v[134:135], v212 offset:37120
    buffer_load_dwordx4 v255, s[20:23], s62 offen lds
    s_waitcnt lgkmcnt(0)
    v_mfma_f32_32x32x16_bf16 v[80:95], v[128:131], a[96:99], v[80:95]
    s_lshl_b32 s62, s81, 4
    s_add_u32 m0, s3, 10240
    ds_read_b64_tr_b16 v[136:137], v213 offset:32768
    ds_read_b64_tr_b16 v[138:139], v213 offset:33024
    buffer_load_dwordx4 v254, s[16:19], s62 offen lds
    v_mfma_f32_16x16x32_bf16 v[192:195], v[204:207], v[128:131], v[192:195]
    s_waitcnt vmcnt(5)
    ds_read_b64_tr_b16 a[224:225], v12 offset:0
    ds_read_b64_tr_b16 a[226:227], v12 offset:512
    ds_read_b64_tr_b16 a[228:229], v12 offset:1024
    v_mfma_f32_32x32x16_bf16 v[96:111], v[132:135], a[96:99], v[96:111]
    s_add_u32 m0, s3, 11264
    ds_read_b64_tr_b16 v[140:141], v213 offset:36864
    ds_read_b64_tr_b16 v[142:143], v213 offset:37120
    buffer_load_dwordx4 v255, s[16:19], s62 offen lds
    v_mfma_f32_16x16x32_bf16 v[196:199], v[204:207], v[132:135], v[196:199]
    ds_read_b64_tr_b16 a[230:231], v12 offset:1536
    ds_read_b64_tr_b16 a[232:233], v12 offset:2048
    ds_read_b64_tr_b16 a[234:235], v12 offset:2560
    s_waitcnt lgkmcnt(3)
    v_mfma_f32_32x32x16_bf16 v[80:95], v[136:139], a[100:103], v[80:95]
    ds_read_b64_tr_b16 v[128:129], v214 offset:32768
    ds_read_b64_tr_b16 v[130:131], v214 offset:33024
    ds_read_b64_tr_b16 a[236:237], v12 offset:3072
    ds_read_b64_tr_b16 a[238:239], v12 offset:3584
    ds_read_b64_tr_b16 a[240:241], v12 offset:4096
    v_mfma_f32_32x32x16_bf16 v[96:111], v[140:143], a[100:103], v[96:111]
    ds_read_b64_tr_b16 v[132:133], v214 offset:36864
    ds_read_b64_tr_b16 v[134:135], v214 offset:37120
    ds_read_b64_tr_b16 a[242:243], v12 offset:4608
    ds_read_b64_tr_b16 a[244:245], v12 offset:5120
    ds_read_b64_tr_b16 a[246:247], v12 offset:5632
    s_waitcnt lgkmcnt(3)
    v_mfma_f32_32x32x16_bf16 v[80:95], v[128:131], a[104:107], v[80:95]
    s_barrier
    buffer_load_dwordx2 v[176:177], v241, s[28:31], 0 offen sc1
    buffer_load_dwordx2 v[228:229], v233, s[28:31], 0 offen sc1
    s_lshl_b32 s62, s36, 17
    s_add_u32 s62, s62, 98304
    s_add_u32 m0, s3, 0
    ds_read_b64_tr_b16 v[136:137], v215 offset:32768
    ds_read_b64_tr_b16 v[138:139], v215 offset:33024
    buffer_load_dwordx4 v254, s[20:23], s62 offen lds
    v_mfma_f32_32x32x16_bf16 v[96:111], v[132:135], a[104:107], v[96:111]
    s_add_u32 m0, s3, 1024
    ds_read_b64_tr_b16 v[140:141], v215 offset:36864
    ds_read_b64_tr_b16 v[142:143], v215 offset:37120
    buffer_load_dwordx4 v255, s[20:23], s62 offen lds
    s_waitcnt lgkmcnt(0)
    v_mfma_f32_32x32x16_bf16 v[80:95], v[136:139], a[108:111], v[80:95]
    s_lshl_b32 s62, s82, 4
    s_add_u32 m0, s3, 2048
    ds_read_b64_tr_b16 v[128:129], v212 offset:49152
    ds_read_b64_tr_b16 v[130:131], v212 offset:49408
    buffer_load_dwordx4 v254, s[16:19], s62 offen lds
    v_mfma_f32_32x32x16_bf16 v[96:111], v[140:143], a[108:111], v[96:111]
    s_add_u32 m0, s3, 3072
    ds_read_b64_tr_b16 v[132:133], v212 offset:53248
    ds_read_b64_tr_b16 v[134:135], v212 offset:53504
    buffer_load_dwordx4 v255, s[16:19], s62 offen lds
    s_waitcnt lgkmcnt(0)
    v_mfma_f32_32x32x16_bf16 v[80:95], v[128:131], a[112:115], v[80:95]
    s_lshl_b32 s62, s36, 17
    s_add_u32 s62, s62, 114688
    s_add_u32 m0, s3, 4096
    ds_read_b64_tr_b16 v[136:137], v213 offset:49152
    ds_read_b64_tr_b16 v[138:139], v213 offset:49408
    buffer_load_dwordx4 v254, s[20:23], s62 offen lds
    v_mfma_f32_16x16x32_bf16 v[192:195], v[204:207], v[128:131], v[192:195]
    v_mfma_f32_32x32x16_bf16 v[96:111], v[132:135], a[112:115], v[96:111]
    s_add_u32 m0, s3, 5120
    ds_read_b64_tr_b16 v[140:141], v213 offset:53248
    ds_read_b64_tr_b16 v[142:143], v213 offset:53504
    buffer_load_dwordx4 v255, s[20:23], s62 offen lds
    v_mfma_f32_16x16x32_bf16 v[196:199], v[204:207], v[132:135], v[196:199]
    s_waitcnt lgkmcnt(0)
    v_mfma_f32_32x32x16_bf16 v[80:95], v[136:139], a[116:119], v[80:95]
    ds_read_b64_tr_b16 v[128:129], v214 offset:49152
    ds_read_b64_tr_b16 v[130:131], v214 offset:49408
    s_nop 3
    v_cvt_pk_bf16_f32 v193, v192, v192
    v_cvt_pk_bf16_f32 v197, v196, v196
    v_and_b32 v193, s69, v193
    v_and_b32 v197, s69, v197
    v_sub_f32 v193, v192, v193
    v_mfma_f32_32x32x16_bf16 v[96:111], v[140:143], a[116:119], v[96:111]
    ds_read_b64_tr_b16 v[132:133], v214 offset:53248
    ds_read_b64_tr_b16 v[134:135], v214 offset:53504
    v_sub_f32 v197, v196, v197
    v_cvt_pk_bf16_f32 v192, v192, v193
    v_cvt_pk_bf16_f32 v196, v196, v197
    ds_write_b32 v3, v192 offset:2048
    ds_write_b32 v3, v196 offset:2560
    s_waitcnt lgkmcnt(2)
    v_mfma_f32_32x32x16_bf16 v[80:95], v[128:131], a[120:123], v[80:95]
    s_waitcnt lgkmcnt(0)
    s_barrier
    ds_read_b64_tr_b16 v[136:137], v215 offset:49152
    ds_read_b64_tr_b16 v[138:139], v215 offset:49408
    ds_read_b128 v[192:195], v6 offset:2048
    ds_read_b128 v[196:199], v6 offset:2560
    v_mfma_f32_32x32x16_bf16 v[96:111], v[132:135], a[120:123], v[96:111]
    ds_read_b64_tr_b16 v[140:141], v215 offset:53248
    ds_read_b64_tr_b16 v[142:143], v215 offset:53504
    s_waitcnt vmcnt(6)
    v_cmp_ne_u64 vcc, s[44:45], v[228:229]
    s_cmp_eq_u64 vcc, 0
    s_cselect_b32 s42, 0, 0x20000000
    v_add_u32 v234, s42, v234
    v_add_u32 v235, s42, v235
    s_waitcnt lgkmcnt(0)
    v_mfma_f32_32x32x16_bf16 v[80:95], v[136:139], a[124:127], v[80:95]
    v_mfma_f32_32x32x16_bf16 v[96:111], v[140:143], a[124:127], v[96:111]
    s_barrier
    v_mfma_f32_32x32x16_bf16 v[80:95], v[192:195], v[8:11], v[80:95]
    v_mfma_f32_32x32x16_bf16 v[96:111], v[196:199], v[8:11], v[96:111]
    s_waitcnt lgkmcnt(0)
    s_mul_i32 s43, s36, 24576
    v_subrev_u32 v238, s3, v12
    v_add_u32 v238, s43, v238
    s_nop 7
    v_cvt_pk_bf16_f32 v80, v80, v81
    v_cvt_pk_bf16_f32 v81, v82, v83
    v_cvt_pk_bf16_f32 v82, v84, v85
    v_cvt_pk_bf16_f32 v83, v86, v87
    v_pk_max_i16 v80, v80, 0
    v_pk_max_i16 v81, v81, 0
    v_pk_max_i16 v82, v82, 0
    v_pk_max_i16 v83, v83, 0
    buffer_store_dwordx4 v[80:83], v4, s[28:31], s51 offen offset:0 sc1
    v_cvt_pk_bf16_f32 v84, v88, v89
    v_cvt_pk_bf16_f32 v85, v90, v91
    v_cvt_pk_bf16_f32 v86, v92, v93
    v_cvt_pk_bf16_f32 v87, v94, v95
    v_pk_max_i16 v84, v84, 0
    v_pk_max_i16 v85, v85, 0
    v_pk_max_i16 v86, v86, 0
    v_pk_max_i16 v87, v87, 0
    buffer_store_dwordx4 v[84:87], v4, s[28:31], s51 offen offset:1024 sc1
    v_cvt_pk_bf16_f32 v96, v96, v97
    v_cvt_pk_bf16_f32 v97, v98, v99
    v_cvt_pk_bf16_f32 v98, v100, v101
    v_cvt_pk_bf16_f32 v99, v102, v103
    v_pk_max_i16 v96, v96, 0
    v_pk_max_i16 v97, v97, 0
    v_pk_max_i16 v98, v98, 0
    v_pk_max_i16 v99, v99, 0
    buffer_store_dwordx4 v[96:99], v4, s[28:31], s52 offen offset:0 sc1
    v_cvt_pk_bf16_f32 v100, v104, v105
    v_cvt_pk_bf16_f32 v101, v106, v107
    v_cvt_pk_bf16_f32 v102, v108, v109
    v_cvt_pk_bf16_f32 v103, v110, v111
    v_pk_max_i16 v100, v100, 0
    v_pk_max_i16 v101, v101, 0
    v_pk_max_i16 v102, v102, 0
    v_pk_max_i16 v103, v103, 0
    buffer_store_dwordx4 v[100:103], v4, s[28:31], s52 offen offset:1024 sc1
    buffer_load_dwordx4 v[16:19], v234, s[28:31], s70 offen
    buffer_load_dwordx4 v[20:23], v235, s[28:31], s70 offen
    buffer_load_dwordx4 v[24:27], v234, s[28:31], s71 offen
    buffer_load_dwordx4 v[28:31], v235, s[28:31], s71 offen
    buffer_load_dwordx4 v[32:35], v234, s[28:31], s72 offen
    buffer_load_dwordx4 v[36:39], v235, s[28:31], s72 offen
    buffer_load_dwordx4 v[40:43], v234, s[28:31], s73 offen
    buffer_load_dwordx4 v[44:47], v235, s[28:31], s73 offen
    buffer_load_dwordx4 v[48:51], v234, s[28:31], s74 offen
    buffer_load_dwordx4 v[52:55], v235, s[28:31], s74 offen
    buffer_load_dwordx4 v[56:59], v234, s[28:31], s75 offen
    buffer_load_dwordx4 v[60:63], v235, s[28:31], s75 offen
    buffer_load_dwordx4 v[64:67], v234, s[28:31], s76 offen
    buffer_load_dwordx4 v[68:71], v235, s[28:31], s76 offen
    buffer_load_dwordx4 v[72:75], v234, s[28:31], s77 offen
    buffer_load_dwordx4 v[76:79], v235, s[28:31], s77 offen
    s_cmp_eq_u32 s42, 0
    s_cbranch_scc1 feok_6
    v_subrev_u32 v234, s42, v234
    v_subrev_u32 v235, s42, v235
    s_waitcnt vmcnt(0)
    v_mov_b32 v244, s44
    v_mov_b32 v245, s45
    v_mov_b32 v246, 14680064
    s_mov_b64 exec, 1
    buffer_store_dwordx2 v[244:245], v246, s[28:31], s41 offen sc1
    s_mov_b64 exec, -1
    s_mov_b32 s67, 0x8000
poll_7:
    buffer_load_dwordx2 v[228:229], v233, s[28:31], 0 offen sc1
    s_waitcnt vmcnt(0)
    v_cmp_ne_u64 vcc, s[44:45], v[228:229]
    s_cbranch_vccz polld_8
    s_sub_u32 s67, s67, 1
    s_cmp_lg_u32 s67, 0
    s_cbranch_scc1 poll_7
polld_8:
    buffer_load_dwordx4 v[16:19], v234, s[28:31], s70 offen
    buffer_load_dwordx4 v[20:23], v235, s[28:31], s70 offen
    buffer_load_dwordx4 v[24:27], v234, s[28:31], s71 offen
    buffer_load_dwordx4 v[28:31], v235, s[28:31], s71 offen
    buffer_load_dwordx4 v[32:35], v234, s[28:31], s72 offen
    buffer_load_dwordx4 v[36:39], v235, s[28:31], s72 offen
    buffer_load_dwordx4 v[40:43], v234, s[28:31], s73 offen
    buffer_load_dwordx4 v[44:47], v235, s[28:31], s73 offen
    buffer_load_dwordx4 v[48:51], v234, s[28:31], s74 offen
    buffer_load_dwordx4 v[52:55], v235, s[28:31], s74 offen
    buffer_load_dwordx4 v[56:59], v234, s[28:31], s75 offen
    buffer_load_dwordx4 v[60:63], v235, s[28:31], s75 offen
    buffer_load_dwordx4 v[64:67], v234, s[28:31], s76 offen
    buffer_load_dwordx4 v[68:71], v235, s[28:31], s76 offen
    buffer_load_dwordx4 v[72:75], v234, s[28:31], s77 offen
    buffer_load_dwordx4 v[76:79], v235, s[28:31], s77 offen
feok_6:
    s_branch L_phase2
L_typeB:
    s_lshr_b32 s57, s38, 1
    s_mul_i32 s57, s57, 896
    s_and_b32 s58, s38, 1
    s_lshl_b32 s59, s58, 7
    s_add_u32 s90, s57, s59
    s_lshl_b32 s56, s38, 7
    v_add_u32 v220, s56, v7
    v_add_u32 v221, 64, v220
    s_lshl_b32 s58, s58, 6
    s_add_u32 s91, s57, s58
    s_add_u32 s91, s91, 256
    v_add_u32 v222, s90, v8
    v_add_u32 v223, 64, v222
    v_add_u32 v224, s91, v8
    v_add_u32 v225, 384, v222
    v_add_u32 v226, 448, v222
    s_add_u32 m0, s46, 0
    s_nop 0
    buffer_load_dwordx4 v228, s[4:7], s40 offen lds
    s_add_u32 m0, s46, 1024
    s_nop 0
    buffer_load_dwordx4 v229, s[4:7], s40 offen lds
    s_add_u32 m0, s46, 2048
    s_nop 0
    buffer_load_dwordx4 v230, s[4:7], s40 offen lds
    s_add_u32 m0, s46, 3072
    s_nop 0
    buffer_load_dwordx4 v231, s[4:7], s40 offen lds
    s_add_u32 m0, s43, 0
    s_nop 0
    buffer_load_dwordx4 v220, s[8:11], s41 offen lds
    s_add_u32 m0, s43, 4096
    s_nop 0
    buffer_load_dwordx4 v221, s[8:11], s41 offen lds
    s_add_u32 m0, s43, 8192
    s_nop 0
    buffer_load_dwordx4 v222, s[12:15], s42 offen lds
    s_add_u32 m0, s43, 12288
    s_nop 0
    buffer_load_dwordx4 v223, s[12:15], s42 offen lds
    s_add_u32 s39, s39, 0x20000000
    s_lshr_b32 s40, s39, 22
    s_mul_hi_u32 s41, s39, 1572864
    s_mul_hi_u32 s42, s39, 1835008
    s_add_u32 m0, s46, 16384
    s_nop 0
    buffer_load_dwordx4 v228, s[4:7], s40 offen lds
    s_add_u32 m0, s46, 17408
    s_nop 0
    buffer_load_dwordx4 v229, s[4:7], s40 offen lds
    s_add_u32 m0, s46, 18432
    s_nop 0
    buffer_load_dwordx4 v230, s[4:7], s40 offen lds
    s_add_u32 m0, s46, 19456
    s_nop 0
    buffer_load_dwordx4 v231, s[4:7], s40 offen lds
    s_add_u32 m0, s43, 16384
    s_nop 0
    buffer_load_dwordx4 v220, s[8:11], s41 offen lds
    s_add_u32 m0, s43, 20480
    s_nop 0
    buffer_load_dwordx4 v221, s[8:11], s41 offen lds
    s_add_u32 m0, s43, 24576
    s_nop 0
    buffer_load_dwordx4 v222, s[12:15], s42 offen lds
    s_add_u32 m0, s43, 28672
    s_nop 0
    buffer_load_dwordx4 v223, s[12:15], s42 offen lds
    s_add_u32 s39, s39, 0x20000000
    s_lshr_b32 s40, s39, 22
    s_mul_hi_u32 s41, s39, 1572864
    s_mul_hi_u32 s42, s39, 1835008
    s_add_u32 m0, s46, 32768
    s_nop 0
    buffer_load_dwordx4 v228, s[4:7], s40 offen lds
    s_add_u32 m0, s46, 33792
    s_nop 0
    buffer_load_dwordx4 v229, s[4:7], s40 offen lds
    s_add_u32 m0, s46, 34816
    s_nop 0
    buffer_load_dwordx4 v230, s[4:7], s40 offen lds
    s_add_u32 m0, s46, 35840
    s_nop 0
    buffer_load_dwordx4 v231, s[4:7], s40 offen lds
    s_add_u32 m0, s43, 32768
    s_nop 0
    buffer_load_dwordx4 v220, s[8:11], s41 offen lds
    s_add_u32 m0, s43, 36864
    s_nop 0
    buffer_load_dwordx4 v221, s[8:11], s41 offen lds
    s_add_u32 m0, s43, 40960
    s_nop 0
    buffer_load_dwordx4 v222, s[12:15], s42 offen lds
    s_add_u32 m0, s43, 45056
    s_nop 0
    buffer_load_dwordx4 v223, s[12:15], s42 offen lds
    s_mov_b32 s20, s76
    s_mov_b32 s21, s77
    s_mov_b32 s22, 524288
    s_mov_b32 s23, 0x00020000
    s_mov_b32 s16, s82
    s_mov_b32 s17, s83
    s_mov_b32 s18, 1835008
    s_mov_b32 s19, 0x00020000
    s_mov_b32 s24, s84
    s_mov_b32 s25, s85
    s_mov_b32 s26, 2097152
    s_mov_b32 s27, 0x00020000
    s_mov_b32 s28, s88
    s_mov_b32 s29, s89
    s_mov_b32 s30, 16777216
    s_mov_b32 s31, 0x00020000
    v_lshrrev_b32 v9, 5, v1
    v_lshlrev_b32 v10, 9, v9
    v_bfe_u32 v11, v1, 2, 2
    v_lshl_add_u32 v10, v11, 6, v10
    v_bfe_u32 v11, v1, 4, 1
    v_lshl_add_u32 v10, v11, 5, v10
    v_and_b32 v11, 3, v1
    v_lshl_add_u32 v10, v11, 3, v10
    v_bfe_u32 v11, v1, 4, 1
    v_lshlrev_b32 v11, 11, v11
    v_and_b32 v12, 15, v1
    v_lshl_add_u32 v11, v12, 6, v11
    v_add_u32 v11, s46, v11
    v_bfe_u32 v12, v1, 2, 2
    s_add_u32 s56, s36, 0
    s_and_b32 s56, s56, 3
    s_lshl_b32 s57, s56, 10
    v_add_u32 v212, s57, v10
    s_and_b32 s57, s56, 1
    s_lshl_b32 s57, s57, 1
    s_lshr_b32 s58, s56, 1
    s_lshl_b32 s58, s58, 10
    v_add_u32 v13, s57, v9
    v_xor_b32 v13, v13, v12
    v_lshl_add_u32 v13, v13, 4, v11
    v_add_u32 v216, s58, v13
    s_add_u32 s56, s36, 1
    s_and_b32 s56, s56, 3
    s_lshl_b32 s57, s56, 10
    v_add_u32 v213, s57, v10
    s_and_b32 s57, s56, 1
    s_lshl_b32 s57, s57, 1
    s_lshr_b32 s58, s56, 1
    s_lshl_b32 s58, s58, 10
    v_add_u32 v13, s57, v9
    v_xor_b32 v13, v13, v12
    v_lshl_add_u32 v13, v13, 4, v11
    v_add_u32 v217, s58, v13
    s_add_u32 s56, s36, 2
    s_and_b32 s56, s56, 3
    s_lshl_b32 s57, s56, 10
    v_add_u32 v214, s57, v10
    s_and_b32 s57, s56, 1
    s_lshl_b32 s57, s57, 1
    s_lshr_b32 s58, s56, 1
    s_lshl_b32 s58, s58, 10
    v_add_u32 v13, s57, v9
    v_xor_b32 v13, v13, v12
    v_lshl_add_u32 v13, v13, 4, v11
    v_add_u32 v218, s58, v13
    s_add_u32 s56, s36, 3
    s_and_b32 s56, s56, 3
    s_lshl_b32 s57, s56, 10
    v_add_u32 v215, s57, v10
    s_and_b32 s57, s56, 1
    s_lshl_b32 s57, s57, 1
    s_lshr_b32 s58, s56, 1
    s_lshl_b32 s58, s58, 10
    v_add_u32 v13, s57, v9
    v_xor_b32 v13, v13, v12
    v_lshl_add_u32 v13, v13, 4, v11
    v_add_u32 v219, s58, v13
    s_mov_b32 s56, 0x3f803f80
    v_mov_b32 v208, s56
    v_mov_b32 v209, s56
    v_mov_b32 v210, s56
    v_mov_b32 v211, s56
    v_bfe_u32 v11, v1, 4, 1
    v_lshlrev_b32 v11, 2, v11
    v_and_b32 v12, 7, v1
    v_cmp_eq_u32 vcc, v11, v12
    v_cndmask_b32 v204, 0, v208, vcc
    v_mov_b32 v205, v204
    v_mov_b32 v206, v204
    v_mov_b32 v207, v204
    s_mov_b32 s54, 0xffff
    s_mov_b32 s55, 0xffff
    s_mov_b32 s100, -1
    s_mov_b32 s101, 0
    s_mov_b32 s66, 0x358637bd
    s_mov_b32 s68, 0x3f317218
    s_mov_b32 s69, 0xffff0000
    s_lshl_b32 s56, s37, 2
    s_add_u32 s56, s56, s36
    s_mul_i32 s57, s56, 114688
    s_lshl_b32 s58, s56, 15
    s_add_u32 s58, s58, 8388608
    v_lshlrev_b32 v11, 4, v1
    v_add_u32 v4, s57, v11
    v_add_u32 v5, s58, v11
    v_and_b32 v6, 31, v1
    v_lshlrev_b32 v6, 4, v6
    v_add_u32 v6, 153600, v6
    s_lshl_b32 s56, s36, 2
    v_add_u32 v3, s56, v6
    v_mov_b32 v243, 0
    s_lshl_b32 s47, s38, 12
    s_add_u32 s48, s47, 2048
    s_lshl_b32 s49, s90, 5
    s_add_u32 s50, s49, 2048
    s_lshl_b32 s51, s91, 5
    s_add_u32 s52, s49, 12288
    s_add_u32 s53, s49, 14336
    s_waitcnt vmcnt(16)
    s_barrier
    ds_read_b64_tr_b16 v[128:129], v212 offset:0
    ds_read_b64_tr_b16 v[130:131], v212 offset:256
    ds_read_b128 a[0:3], v216 offset:0
    ds_read_b64_tr_b16 v[132:133], v212 offset:4096
    ds_read_b64_tr_b16 v[134:135], v212 offset:4352
    ds_read_b64_tr_b16 v[136:137], v212 offset:8192
    ds_read_b64_tr_b16 v[138:139], v212 offset:8448
    ds_read_b64_tr_b16 v[140:141], v212 offset:12288
    ds_read_b64_tr_b16 v[142:143], v212 offset:12544
    s_waitcnt lgkmcnt(4)
    v_mfma_f32_32x32x16_bf16 v[16:31], v[128:131], a[0:3], 0
    ds_read_b64_tr_b16 v[144:145], v213 offset:0
    ds_read_b64_tr_b16 v[146:147], v213 offset:256
    ds_read_b128 a[4:7], v217 offset:0
    v_mfma_f32_16x16x32_bf16 v[176:179], v[204:207], v[128:131], 0
    s_lshl_b32 s56, s2, 2
    s_add_u32 s56, s56, s36
    v_lshrrev_b32 v244, 2, v1
    v_and_b32 v245, 3, v1
    v_mfma_f32_32x32x16_bf16 v[32:47], v[132:135], a[0:3], 0
    ds_read_b64_tr_b16 v[148:149], v213 offset:4096
    ds_read_b64_tr_b16 v[150:151], v213 offset:4352
    v_mfma_f32_16x16x32_bf16 v[180:183], v[204:207], v[132:135], 0
    s_mul_i32 s57, s56, 1792
    v_lshlrev_b32 v245, 4, v245
    v_lshl_add_u32 v244, v244, 10, v245
    s_waitcnt lgkmcnt(5)
    v_mfma_f32_32x32x16_bf16 v[48:63], v[136:139], a[0:3], 0
    ds_read_b64_tr_b16 v[152:153], v213 offset:8192
    ds_read_b64_tr_b16 v[154:155], v213 offset:8448
    v_mfma_f32_16x16x32_bf16 v[184:187], v[204:207], v[136:139], 0
    v_min_u32 v248, 13, v1
    s_lshl_b32 s58, s65, 7
    s_and_b32 s59, s36, 1
    v_mfma_f32_32x32x16_bf16 v[64:79], v[140:143], a[0:3], 0
    ds_read_b64_tr_b16 v[156:157], v213 offset:12288
    ds_read_b64_tr_b16 v[158:159], v213 offset:12544
    v_mfma_f32_16x16x32_bf16 v[188:191], v[204:207], v[140:143], 0
    v_lshlrev_b32 v248, 7, v248
    s_lshl_b32 s59, s59, 6
    s_add_u32 s60, s58, s59
    v_mfma_f32_4x4x4_16b_bf16 v[160:163], a[0:1], v[208:209], 0
    s_xor_b32 s59, s59, 64
    v_mfma_f32_4x4x4_16b_bf16 v[164:167], a[0:1], a[0:1], 0
    s_add_u32 s59, s58, s59
    v_mfma_f32_4x4x4_16b_bf16 v[168:171], a[2:3], v[208:209], 0
    v_add_u32 v254, s60, v244
    v_mfma_f32_4x4x4_16b_bf16 v[172:175], a[2:3], a[2:3], 0
    v_add_u32 v255, s59, v244
    s_waitcnt lgkmcnt(4)
    v_mfma_f32_32x32x16_bf16 v[16:31], v[144:147], a[4:7], v[16:31]
    ds_read_b64_tr_b16 v[128:129], v214 offset:0
    ds_read_b64_tr_b16 v[130:131], v214 offset:256
    ds_read_b128 a[8:11], v218 offset:0
    buffer_load_dword v249, v248, s[16:19], s57 offen
    s_mul_i32 s3, s36, 12288
    v_mfma_f32_32x32x16_bf16 v[32:47], v[148:151], a[4:7], v[32:47]
    ds_read_b64_tr_b16 v[132:133], v214 offset:4096
    ds_read_b64_tr_b16 v[134:135], v214 offset:4352
    s_lshl_b32 s57, s56, 9
    s_add_u32 s3, s3, 98304
    s_waitcnt lgkmcnt(5)
    v_mfma_f32_32x32x16_bf16 v[48:63], v[152:155], a[4:7], v[48:63]
    ds_read_b64_tr_b16 v[136:137], v214 offset:8192
    ds_read_b64_tr_b16 v[138:139], v214 offset:8448
    v_and_b32 v248, 0x180, v248
    v_lshrrev_b32 v244, 5, v1
    v_mfma_f32_32x32x16_bf16 v[64:79], v[156:159], a[4:7], v[64:79]
    ds_read_b64_tr_b16 v[140:141], v214 offset:12288
    ds_read_b64_tr_b16 v[142:143], v214 offset:12544
    buffer_load_dword v250, v248, s[20:23], s57 offen
    v_lshlrev_b32 v244, 8, v244
    v_mfma_f32_4x4x4_16b_bf16 v[160:163], a[4:5], v[208:209], v[160:163]
    v_bfe_u32 v245, v1, 2, 2
    v_mfma_f32_4x4x4_16b_bf16 v[164:167], a[4:5], a[4:5], v[164:167]
    v_lshl_add_u32 v244, v245, 6, v244
    v_mfma_f32_4x4x4_16b_bf16 v[168:171], a[6:7], v[208:209], v[168:171]
    v_bfe_u32 v245, v1, 4, 1
    v_mfma_f32_4x4x4_16b_bf16 v[172:175], a[6:7], a[6:7], v[172:175]
    v_lshl_add_u32 v244, v245, 5, v244
    s_waitcnt lgkmcnt(4)
    v_mfma_f32_32x32x16_bf16 v[16:31], v[128:131], a[8:11], v[16:31]
    ds_read_b64_tr_b16 v[144:145], v215 offset:0
    ds_read_b64_tr_b16 v[146:147], v215 offset:256
    ds_read_b128 a[12:15], v219 offset:0
    v_mfma_f32_32x32x16_bf16 v[32:47], v[132:135], a[8:11], v[32:47]
    ds_read_b64_tr_b16 v[148:149], v215 offset:4096
    ds_read_b64_tr_b16 v[150:151], v215 offset:4352
    s_waitcnt lgkmcnt(5)
    v_mfma_f32_32x32x16_bf16 v[48:63], v[136:139], a[8:11], v[48:63]
    ds_read_b64_tr_b16 v[152:153], v215 offset:8192
    ds_read_b64_tr_b16 v[154:155], v215 offset:8448
    v_mfma_f32_32x32x16_bf16 v[64:79], v[140:143], a[8:11], v[64:79]
    s_waitcnt vmcnt(10)
    s_barrier
    s_add_u32 s39, s39, 0x20000000
    s_lshr_b32 s40, s39, 22
    s_mul_hi_u32 s41, s39, 1572864
    s_mul_hi_u32 s42, s39, 1835008
    s_add_u32 m0, s46, 49152
    ds_read_b64_tr_b16 v[156:157], v215 offset:12288
    ds_read_b64_tr_b16 v[158:159], v215 offset:12544
    buffer_load_dwordx4 v228, s[4:7], s40 offen lds
    v_mfma_f32_4x4x4_16b_bf16 v[160:163], a[8:9], v[208:209], v[160:163]
    v_and_b32 v245, 3, v1
    v_mfma_f32_4x4x4_16b_bf16 v[164:167], a[8:9], a[8:9], v[164:167]
    v_lshl_add_u32 v244, v245, 3, v244
    v_mfma_f32_4x4x4_16b_bf16 v[168:171], a[10:11], v[208:209], v[168:171]
    v_add_u32 v12, s3, v244
    v_mfma_f32_4x4x4_16b_bf16 v[172:175], a[10:11], a[10:11], v[172:175]
    s_mul_i32 s60, s36, 28672
    s_waitcnt lgkmcnt(4)
    v_mfma_f32_32x32x16_bf16 v[16:31], v[144:147], a[12:15], v[16:31]
    s_add_u32 m0, s46, 50176
    ds_read_b64_tr_b16 v[128:129], v212 offset:16384
    ds_read_b64_tr_b16 v[130:131], v212 offset:16640
    ds_read_b128 a[16:19], v216 offset:16384
    buffer_load_dwordx4 v229, s[4:7], s40 offen lds
    v_mfma_f32_32x32x16_bf16 v[32:47], v[148:151], a[12:15], v[32:47]
    s_add_u32 m0, s46, 51200
    ds_read_b64_tr_b16 v[132:133], v212 offset:20480
    ds_read_b64_tr_b16 v[134:135], v212 offset:20736
    buffer_load_dwordx4 v230, s[4:7], s40 offen lds
    s_waitcnt lgkmcnt(5)
    v_mfma_f32_32x32x16_bf16 v[48:63], v[152:155], a[12:15], v[48:63]
    s_add_u32 m0, s46, 52224
    ds_read_b64_tr_b16 v[136:137], v212 offset:24576
    ds_read_b64_tr_b16 v[138:139], v212 offset:24832
    buffer_load_dwordx4 v231, s[4:7], s40 offen lds
    v_mfma_f32_32x32x16_bf16 v[64:79], v[156:159], a[12:15], v[64:79]
    s_add_u32 m0, s43, 49152
    ds_read_b64_tr_b16 v[140:141], v212 offset:28672
    ds_read_b64_tr_b16 v[142:143], v212 offset:28928
    buffer_load_dwordx4 v220, s[8:11], s41 offen lds
    v_mfma_f32_4x4x4_16b_bf16 v[160:163], a[12:13], v[208:209], v[160:163]
    s_and_b32 s58, s64, 3
    v_mfma_f32_4x4x4_16b_bf16 v[164:167], a[12:13], a[12:13], v[164:167]
    s_mul_i32 s58, s58, 3
    v_mfma_f32_4x4x4_16b_bf16 v[168:171], a[14:15], v[208:209], v[168:171]
    s_and_b32 s59, s65, 7
    v_mfma_f32_4x4x4_16b_bf16 v[172:175], a[14:15], a[14:15], v[172:175]
    s_mul_i32 s59, s59, 3
    s_waitcnt lgkmcnt(4)
    v_mfma_f32_32x32x16_bf16 v[16:31], v[128:131], a[16:19], v[16:31]
    s_add_u32 m0, s43, 53248
    ds_read_b64_tr_b16 v[144:145], v213 offset:16384
    ds_read_b64_tr_b16 v[146:147], v213 offset:16640
    ds_read_b128 a[20:23], v217 offset:16384
    buffer_load_dwordx4 v221, s[8:11], s41 offen lds
    v_mfma_f32_16x16x32_bf16 v[176:179], v[204:207], v[128:131], v[176:179]
    s_lshr_b32 s59, s59, 1
    s_add_u32 s58, s58, s59
    v_mfma_f32_32x32x16_bf16 v[32:47], v[132:135], a[16:19], v[32:47]
    s_add_u32 m0, s43, 57344
    ds_read_b64_tr_b16 v[148:149], v213 offset:20480
    ds_read_b64_tr_b16 v[150:151], v213 offset:20736
    buffer_load_dwordx4 v222, s[12:15], s42 offen lds
    v_mfma_f32_16x16x32_bf16 v[180:183], v[204:207], v[132:135], v[180:183]
    s_cmp_ge_u32 s58, 12
    s_cselect_b32 s59, 12, 0
    s_sub_u32 s58, s58, s59
    s_waitcnt lgkmcnt(5)
    v_mfma_f32_32x32x16_bf16 v[48:63], v[136:139], a[16:19], v[48:63]
    s_add_u32 m0, s43, 61440
    ds_read_b64_tr_b16 v[152:153], v213 offset:24576
    ds_read_b64_tr_b16 v[154:155], v213 offset:24832
    buffer_load_dwordx4 v223, s[12:15], s42 offen lds
    v_mfma_f32_16x16x32_bf16 v[184:187], v[204:207], v[136:139], v[184:187]
    s_lshl_b32 s58, s58, 10
    s_add_u32 s70, s58, s60
    v_mfma_f32_32x32x16_bf16 v[64:79], v[140:143], a[16:19], v[64:79]
    ds_read_b64_tr_b16 v[156:157], v213 offset:28672
    ds_read_b64_tr_b16 v[158:159], v213 offset:28928
    v_mfma_f32_16x16x32_bf16 v[188:191], v[204:207], v[140:143], v[188:191]
    s_add_u32 s61, s60, 12288
    s_add_u32 s71, s70, 1024
    v_mfma_f32_4x4x4_16b_bf16 v[160:163], a[16:17], v[208:209], v[160:163]
    s_cmp_eq_u32 s71, s61
    s_cselect_b32 s71, s60, s71
    v_mfma_f32_4x4x4_16b_bf16 v[164:167], a[16:17], a[16:17], v[164:167]
    s_add_u32 s72, s71, 1024
    v_mfma_f32_4x4x4_16b_bf16 v[168:171], a[18:19], v[208:209], v[168:171]
    s_cmp_eq_u32 s72, s61
    s_cselect_b32 s72, s60, s72
    v_mfma_f32_4x4x4_16b_bf16 v[172:175], a[18:19], a[18:19], v[172:175]
    s_add_u32 s73, s72, 1024
    s_waitcnt lgkmcnt(4)
    v_mfma_f32_32x32x16_bf16 v[16:31], v[144:147], a[20:23], v[16:31]
    ds_read_b64_tr_b16 v[128:129], v214 offset:16384
    ds_read_b64_tr_b16 v[130:131], v214 offset:16640
    ds_read_b128 a[24:27], v218 offset:16384
    s_cmp_eq_u32 s73, s61
    s_cselect_b32 s73, s60, s73
    v_mfma_f32_32x32x16_bf16 v[32:47], v[148:151], a[20:23], v[32:47]
    ds_read_b64_tr_b16 v[132:133], v214 offset:20480
    ds_read_b64_tr_b16 v[134:135], v214 offset:20736
    s_add_u32 s74, s73, 1024
    s_waitcnt lgkmcnt(5)
    v_mfma_f32_32x32x16_bf16 v[48:63], v[152:155], a[20:23], v[48:63]
    ds_read_b64_tr_b16 v[136:137], v214 offset:24576
    ds_read_b64_tr_b16 v[138:139], v214 offset:24832
    s_cmp_eq_u32 s74, s61
    s_cselect_b32 s74, s60, s74
    v_mfma_f32_32x32x16_bf16 v[64:79], v[156:159], a[20:23], v[64:79]
    ds_read_b64_tr_b16 v[140:141], v214 offset:28672
    ds_read_b64_tr_b16 v[142:143], v214 offset:28928
    s_add_u32 s75, s74, 1024
    v_mfma_f32_4x4x4_16b_bf16 v[160:163], a[20:21], v[208:209], v[160:163]
    s_cmp_eq_u32 s75, s61
    s_cselect_b32 s75, s60, s75
    v_mfma_f32_4x4x4_16b_bf16 v[164:167], a[20:21], a[20:21], v[164:167]
    s_add_u32 s76, s75, 1024
    v_mfma_f32_4x4x4_16b_bf16 v[168:171], a[22:23], v[208:209], v[168:171]
    s_cmp_eq_u32 s76, s61
    s_cselect_b32 s76, s60, s76
    v_mfma_f32_4x4x4_16b_bf16 v[172:175], a[22:23], a[22:23], v[172:175]
    s_add_u32 s77, s76, 1024
    s_waitcnt lgkmcnt(4)
    v_mfma_f32_32x32x16_bf16 v[16:31], v[128:131], a[24:27], v[16:31]
    ds_read_b64_tr_b16 v[144:145], v215 offset:16384
    ds_read_b64_tr_b16 v[146:147], v215 offset:16640
    ds_read_b128 a[28:31], v219 offset:16384
    v_mfma_f32_32x32x16_bf16 v[32:47], v[132:135], a[24:27], v[32:47]
    ds_read_b64_tr_b16 v[148:149], v215 offset:20480
    ds_read_b64_tr_b16 v[150:151], v215 offset:20736
    s_waitcnt lgkmcnt(5)
    v_mfma_f32_32x32x16_bf16 v[48:63], v[136:139], a[24:27], v[48:63]
    ds_read_b64_tr_b16 v[152:153], v215 offset:24576
    ds_read_b64_tr_b16 v[154:155], v215 offset:24832
    v_mfma_f32_32x32x16_bf16 v[64:79], v[140:143], a[24:27], v[64:79]
    s_waitcnt vmcnt(10)
    s_barrier
    s_add_u32 s39, s39, 0x20000000
    s_lshr_b32 s40, s39, 22
    s_mul_hi_u32 s41, s39, 1572864
    s_mul_hi_u32 s42, s39, 1835008
    s_add_u32 m0, s46, 0
    ds_read_b64_tr_b16 v[156:157], v215 offset:28672
    ds_read_b64_tr_b16 v[158:159], v215 offset:28928
    buffer_load_dwordx4 v228, s[4:7], s40 offen lds
    v_mfma_f32_4x4x4_16b_bf16 v[160:163], a[24:25], v[208:209], v[160:163]
    s_cmp_eq_u32 s77, s61
    s_cselect_b32 s77, s60, s77
    v_mfma_f32_4x4x4_16b_bf16 v[164:167], a[24:25], a[24:25], v[164:167]
    s_add_u32 s78, s77, 1024
    v_mfma_f32_4x4x4_16b_bf16 v[168:171], a[26:27], v[208:209], v[168:171]
    s_cmp_eq_u32 s78, s61
    s_cselect_b32 s78, s60, s78
    v_mfma_f32_4x4x4_16b_bf16 v[172:175], a[26:27], a[26:27], v[172:175]
    s_add_u32 s79, s78, 1024
    s_waitcnt lgkmcnt(4)
    v_mfma_f32_32x32x16_bf16 v[16:31], v[144:147], a[28:31], v[16:31]
    s_add_u32 m0, s46, 1024
    ds_read_b64_tr_b16 v[128:129], v212 offset:32768
    ds_read_b64_tr_b16 v[130:131], v212 offset:33024
    ds_read_b128 a[32:35], v216 offset:32768
    buffer_load_dwordx4 v229, s[4:7], s40 offen lds
    v_mfma_f32_32x32x16_bf16 v[32:47], v[148:151], a[28:31], v[32:47]
    s_add_u32 m0, s46, 2048
    ds_read_b64_tr_b16 v[132:133], v212 offset:36864
    ds_read_b64_tr_b16 v[134:135], v212 offset:37120
    buffer_load_dwordx4 v230, s[4:7], s40 offen lds
    s_waitcnt lgkmcnt(5)
    v_mfma_f32_32x32x16_bf16 v[48:63], v[152:155], a[28:31], v[48:63]
    s_add_u32 m0, s46, 3072
    ds_read_b64_tr_b16 v[136:137], v212 offset:40960
    ds_read_b64_tr_b16 v[138:139], v212 offset:41216
    buffer_load_dwordx4 v231, s[4:7], s40 offen lds
    v_mfma_f32_32x32x16_bf16 v[64:79], v[156:159], a[28:31], v[64:79]
    s_add_u32 m0, s43, 0
    ds_read_b64_tr_b16 v[140:141], v212 offset:45056
    ds_read_b64_tr_b16 v[142:143], v212 offset:45312
    buffer_load_dwordx4 v220, s[8:11], s41 offen lds
    v_mfma_f32_4x4x4_16b_bf16 v[160:163], a[28:29], v[208:209], v[160:163]
    s_cmp_eq_u32 s79, s61
    s_cselect_b32 s79, s60, s79
    v_mfma_f32_4x4x4_16b_bf16 v[164:167], a[28:29], a[28:29], v[164:167]
    s_add_u32 s80, s79, 1024
    v_mfma_f32_4x4x4_16b_bf16 v[168:171], a[30:31], v[208:209], v[168:171]
    s_cmp_eq_u32 s80, s61
    s_cselect_b32 s80, s60, s80
    v_mfma_f32_4x4x4_16b_bf16 v[172:175], a[30:31], a[30:31], v[172:175]
    s_add_u32 s81, s80, 1024
    s_waitcnt lgkmcnt(4)
    v_mfma_f32_32x32x16_bf16 v[16:31], v[128:131], a[32:35], v[16:31]
    s_add_u32 m0, s43, 4096
    ds_read_b64_tr_b16 v[144:145], v213 offset:32768
    ds_read_b64_tr_b16 v[146:147], v213 offset:33024
    ds_read_b128 a[36:39], v217 offset:32768
    buffer_load_dwordx4 v221, s[8:11], s41 offen lds
    v_mfma_f32_16x16x32_bf16 v[176:179], v[204:207], v[128:131], v[176:179]
    s_cmp_eq_u32 s81, s61
    s_cselect_b32 s81, s60, s81
    s_and_b32 s58, s64, 3
    v_mfma_f32_32x32x16_bf16 v[32:47], v[132:135], a[32:35], v[32:47]
    s_add_u32 m0, s43, 8192
    ds_read_b64_tr_b16 v[148:149], v213 offset:36864
    ds_read_b64_tr_b16 v[150:151], v213 offset:37120
    buffer_load_dwordx4 v222, s[12:15], s42 offen lds
    v_mfma_f32_16x16x32_bf16 v[180:183], v[204:207], v[132:135], v[180:183]
    s_lshl_b32 s58, s58, 1
    s_add_u32 s58, s58, s65
    s_waitcnt lgkmcnt(5)
    v_mfma_f32_32x32x16_bf16 v[48:63], v[136:139], a[32:35], v[48:63]
    s_add_u32 m0, s43, 12288
    ds_read_b64_tr_b16 v[152:153], v213 offset:40960
    ds_read_b64_tr_b16 v[154:155], v213 offset:41216
    buffer_load_dwordx4 v223, s[12:15], s42 offen lds
    v_mfma_f32_16x16x32_bf16 v[184:187], v[204:207], v[136:139], v[184:187]
    s_lshl_b32 s58, s58, 11
    s_and_b32 s58, s58, 0x3c00
    v_mfma_f32_32x32x16_bf16 v[64:79], v[140:143], a[32:35], v[64:79]
    ds_read_b64_tr_b16 v[156:157], v213 offset:45056
    ds_read_b64_tr_b16 v[158:159], v213 offset:45312
    v_mfma_f32_16x16x32_bf16 v[188:191], v[204:207], v[140:143], v[188:191]
    s_add_u32 s82, s58, s61
    s_add_u32 s58, s58, 1024
    v_mfma_f32_4x4x4_16b_bf16 v[160:163], a[32:33], v[208:209], v[160:163]
    s_and_b32 s58, s58, 0x3c00
    v_mfma_f32_4x4x4_16b_bf16 v[164:167], a[32:33], a[32:33], v[164:167]
    s_add_u32 s83, s58, s61
    v_mfma_f32_4x4x4_16b_bf16 v[168:171], a[34:35], v[208:209], v[168:171]
    s_add_u32 s58, s58, 1024
    v_mfma_f32_4x4x4_16b_bf16 v[172:175], a[34:35], a[34:35], v[172:175]
    s_and_b32 s58, s58, 0x3c00
    s_waitcnt lgkmcnt(4)
    v_mfma_f32_32x32x16_bf16 v[16:31], v[144:147], a[36:39], v[16:31]
    ds_read_b64_tr_b16 v[128:129], v214 offset:32768
    ds_read_b64_tr_b16 v[130:131], v214 offset:33024
    ds_read_b128 a[40:43], v218 offset:32768
    s_add_u32 s84, s58, s61
    v_mfma_f32_32x32x16_bf16 v[32:47], v[148:151], a[36:39], v[32:47]
    ds_read_b64_tr_b16 v[132:133], v214 offset:36864
    ds_read_b64_tr_b16 v[134:135], v214 offset:37120
    s_add_u32 s58, s58, 1024
    s_waitcnt lgkmcnt(5)
    v_mfma_f32_32x32x16_bf16 v[48:63], v[152:155], a[36:39], v[48:63]
    ds_read_b64_tr_b16 v[136:137], v214 offset:40960
    ds_read_b64_tr_b16 v[138:139], v214 offset:41216
    s_and_b32 s58, s58, 0x3c00
    v_mfma_f32_32x32x16_bf16 v[64:79], v[156:159], a[36:39], v[64:79]
    ds_read_b64_tr_b16 v[140:141], v214 offset:45056
    ds_read_b64_tr_b16 v[142:143], v214 offset:45312
    s_add_u32 s85, s58, s61
    v_mfma_f32_4x4x4_16b_bf16 v[160:163], a[36:37], v[208:209], v[160:163]
    s_add_u32 s58, s58, 1024
    v_mfma_f32_4x4x4_16b_bf16 v[164:167], a[36:37], a[36:37], v[164:167]
    s_and_b32 s58, s58, 0x3c00
    v_mfma_f32_4x4x4_16b_bf16 v[168:171], a[38:39], v[208:209], v[168:171]
    s_add_u32 s86, s58, s61
    v_mfma_f32_4x4x4_16b_bf16 v[172:175], a[38:39], a[38:39], v[172:175]
    s_add_u32 s58, s58, 1024
    s_waitcnt lgkmcnt(4)
    v_mfma_f32_32x32x16_bf16 v[16:31], v[128:131], a[40:43], v[16:31]
    ds_read_b64_tr_b16 v[144:145], v215 offset:32768
    ds_read_b64_tr_b16 v[146:147], v215 offset:33024
    ds_read_b128 a[44:47], v219 offset:32768
    v_mfma_f32_32x32x16_bf16 v[32:47], v[132:135], a[40:43], v[32:47]
    ds_read_b64_tr_b16 v[148:149], v215 offset:36864
    ds_read_b64_tr_b16 v[150:151], v215 offset:37120
    s_waitcnt lgkmcnt(5)
    v_mfma_f32_32x32x16_bf16 v[48:63], v[136:139], a[40:43], v[48:63]
    ds_read_b64_tr_b16 v[152:153], v215 offset:40960
    ds_read_b64_tr_b16 v[154:155], v215 offset:41216
    v_mfma_f32_32x32x16_bf16 v[64:79], v[140:143], a[40:43], v[64:79]
    s_waitcnt vmcnt(8)
    s_barrier
    s_add_u32 s39, s39, 0x20000000
    s_lshr_b32 s40, s39, 22
    s_mul_hi_u32 s41, s39, 1572864
    s_mul_hi_u32 s42, s39, 1835008
    s_add_u32 m0, s46, 16384
    ds_read_b64_tr_b16 v[156:157], v215 offset:45056
    ds_read_b64_tr_b16 v[158:159], v215 offset:45312
    buffer_load_dwordx4 v228, s[4:7], s40 offen lds
    v_mfma_f32_4x4x4_16b_bf16 v[160:163], a[40:41], v[208:209], v[160:163]
    s_and_b32 s58, s58, 0x3c00
    v_mfma_f32_4x4x4_16b_bf16 v[164:167], a[40:41], a[40:41], v[164:167]
    s_add_u32 s87, s58, s61
    v_mfma_f32_4x4x4_16b_bf16 v[168:171], a[42:43], v[208:209], v[168:171]
    s_add_u32 s58, s58, 1024
    v_mfma_f32_4x4x4_16b_bf16 v[172:175], a[42:43], a[42:43], v[172:175]
    s_and_b32 s58, s58, 0x3c00
    s_waitcnt lgkmcnt(4)
    v_mfma_f32_32x32x16_bf16 v[16:31], v[144:147], a[44:47], v[16:31]
    s_add_u32 m0, s46, 17408
    ds_read_b64_tr_b16 v[128:129], v212 offset:49152
    ds_read_b64_tr_b16 v[130:131], v212 offset:49408
    ds_read_b128 a[48:51], v216 offset:49152
    buffer_load_dwordx4 v229, s[4:7], s40 offen lds
    v_mfma_f32_32x32x16_bf16 v[32:47], v[148:151], a[44:47], v[32:47]
    s_add_u32 m0, s46, 18432
    ds_read_b64_tr_b16 v[132:133], v212 offset:53248
    ds_read_b64_tr_b16 v[134:135], v212 offset:53504
    buffer_load_dwordx4 v230, s[4:7], s40 offen lds
    s_waitcnt lgkmcnt(5)
    v_mfma_f32_32x32x16_bf16 v[48:63], v[152:155], a[44:47], v[48:63]
    s_add_u32 m0, s46, 19456
    ds_read_b64_tr_b16 v[136:137], v212 offset:57344
    ds_read_b64_tr_b16 v[138:139], v212 offset:57600
    buffer_load_dwordx4 v231, s[4:7], s40 offen lds
    v_mfma_f32_32x32x16_bf16 v[64:79], v[156:159], a[44:47], v[64:79]
    s_add_u32 m0, s43, 16384
    ds_read_b64_tr_b16 v[140:141], v212 offset:61440
    ds_read_b64_tr_b16 v[142:143], v212 offset:61696
    buffer_load_dwordx4 v220, s[8:11], s41 offen lds
    v_mfma_f32_4x4x4_16b_bf16 v[160:163], a[44:45], v[208:209], v[160:163]
    s_add_u32 s88, s58, s61
    v_mfma_f32_4x4x4_16b_bf16 v[164:167], a[44:45], a[44:45], v[164:167]
    s_add_u32 s58, s58, 1024
    v_mfma_f32_4x4x4_16b_bf16 v[168:171], a[46:47], v[208:209], v[168:171]
    s_and_b32 s58, s58, 0x3c00
    v_mfma_f32_4x4x4_16b_bf16 v[172:175], a[46:47], a[46:47], v[172:175]
    s_add_u32 s89, s58, s61
    s_waitcnt lgkmcnt(4)
    v_mfma_f32_32x32x16_bf16 v[16:31], v[128:131], a[48:51], v[16:31]
    s_add_u32 m0, s43, 20480
    ds_read_b64_tr_b16 v[144:145], v213 offset:49152
    ds_read_b64_tr_b16 v[146:147], v213 offset:49408
    ds_read_b128 a[52:55], v217 offset:49152
    buffer_load_dwordx4 v221, s[8:11], s41 offen lds
    v_mfma_f32_16x16x32_bf16 v[176:179], v[204:207], v[128:131], v[176:179]
    buffer_load_dwordx2 v[250:251], v243, s[32:35], 0 offen sc1
    s_add_u32 s58, s58, 1024
    s_and_b32 s58, s58, 0x3c00
    v_mfma_f32_32x32x16_bf16 v[32:47], v[132:135], a[48:51], v[32:47]
    s_add_u32 m0, s43, 24576
    ds_read_b64_tr_b16 v[148:149], v213 offset:53248
    ds_read_b64_tr_b16 v[150:151], v213 offset:53504
    buffer_load_dwordx4 v222, s[12:15], s42 offen lds
    v_mfma_f32_16x16x32_bf16 v[180:183], v[204:207], v[132:135], v[180:183]
    s_add_u32 s90, s58, s61
    s_add_u32 s58, s58, 1024
    s_waitcnt lgkmcnt(5)
    v_mfma_f32_32x32x16_bf16 v[48:63], v[136:139], a[48:51], v[48:63]
    s_add_u32 m0, s43, 28672
    ds_read_b64_tr_b16 v[152:153], v213 offset:57344
    ds_read_b64_tr_b16 v[154:155], v213 offset:57600
    buffer_load_dwordx4 v223, s[12:15], s42 offen lds
    v_mfma_f32_16x16x32_bf16 v[184:187], v[204:207], v[136:139], v[184:187]
    s_and_b32 s58, s58, 0x3c00
    s_add_u32 s91, s58, s61
    v_mfma_f32_32x32x16_bf16 v[64:79], v[140:143], a[48:51], v[64:79]
    ds_read_b64_tr_b16 v[156:157], v213 offset:61440
    ds_read_b64_tr_b16 v[158:159], v213 offset:61696
    v_mfma_f32_16x16x32_bf16 v[188:191], v[204:207], v[140:143], v[188:191]
    s_add_u32 s58, s58, 1024
    s_and_b32 s58, s58, 0x3c00
    v_mfma_f32_4x4x4_16b_bf16 v[160:163], a[48:49], v[208:209], v[160:163]
    s_add_u32 s92, s58, s61
    v_mfma_f32_4x4x4_16b_bf16 v[164:167], a[48:49], a[48:49], v[164:167]
    s_add_u32 s58, s58, 1024
    v_mfma_f32_4x4x4_16b_bf16 v[168:171], a[50:51], v[208:209], v[168:171]
    s_and_b32 s58, s58, 0x3c00
    v_mfma_f32_4x4x4_16b_bf16 v[172:175], a[50:51], a[50:51], v[172:175]
    s_add_u32 s93, s58, s61
    s_waitcnt lgkmcnt(4)
    v_mfma_f32_32x32x16_bf16 v[16:31], v[144:147], a[52:55], v[16:31]
    ds_read_b64_tr_b16 v[128:129], v214 offset:49152
    ds_read_b64_tr_b16 v[130:131], v214 offset:49408
    ds_read_b128 a[56:59], v218 offset:49152
    s_add_u32 s58, s58, 1024
    v_mfma_f32_32x32x16_bf16 v[32:47], v[148:151], a[52:55], v[32:47]
    ds_read_b64_tr_b16 v[132:133], v214 offset:53248
    ds_read_b64_tr_b16 v[134:135], v214 offset:53504
    s_and_b32 s58, s58, 0x3c00
    s_waitcnt lgkmcnt(5)
    v_mfma_f32_32x32x16_bf16 v[48:63], v[152:155], a[52:55], v[48:63]
    ds_read_b64_tr_b16 v[136:137], v214 offset:57344
    ds_read_b64_tr_b16 v[138:139], v214 offset:57600
    s_add_u32 s94, s58, s61
    v_mfma_f32_32x32x16_bf16 v[64:79], v[156:159], a[52:55], v[64:79]
    ds_read_b64_tr_b16 v[140:141], v214 offset:61440
    ds_read_b64_tr_b16 v[142:143], v214 offset:61696
    s_add_u32 s58, s58, 1024
    v_mfma_f32_4x4x4_16b_bf16 v[160:163], a[52:53], v[208:209], v[160:163]
    s_and_b32 s58, s58, 0x3c00
    v_mfma_f32_4x4x4_16b_bf16 v[164:167], a[52:53], a[52:53], v[164:167]
    s_add_u32 s95, s58, s61
    v_mfma_f32_4x4x4_16b_bf16 v[168:171], a[54:55], v[208:209], v[168:171]
    s_add_u32 s58, s58, 1024
    v_mfma_f32_4x4x4_16b_bf16 v[172:175], a[54:55], a[54:55], v[172:175]
    s_and_b32 s58, s58, 0x3c00
    s_waitcnt lgkmcnt(4)
    v_mfma_f32_32x32x16_bf16 v[16:31], v[128:131], a[56:59], v[16:31]
    ds_read_b64_tr_b16 v[144:145], v215 offset:49152
    ds_read_b64_tr_b16 v[146:147], v215 offset:49408
    ds_read_b128 a[60:63], v219 offset:49152
    v_mfma_f32_32x32x16_bf16 v[32:47], v[132:135], a[56:59], v[32:47]
    ds_read_b64_tr_b16 v[148:149], v215 offset:53248
    ds_read_b64_tr_b16 v[150:151], v215 offset:53504
    s_waitcnt lgkmcnt(5)
    v_mfma_f32_32x32x16_bf16 v[48:63], v[136:139], a[56:59], v[48:63]
    ds_read_b64_tr_b16 v[152:153], v215 offset:57344
    ds_read_b64_tr_b16 v[154:155], v215 offset:57600
    v_mfma_f32_32x32x16_bf16 v[64:79], v[140:143], a[56:59], v[64:79]
    s_waitcnt vmcnt(9)
    s_barrier
    s_add_u32 s39, s39, 0x20000000
    s_lshr_b32 s40, s39, 22
    s_mul_hi_u32 s41, s39, 1572864
    s_mul_hi_u32 s42, s39, 1835008
    s_add_u32 m0, s46, 32768
    ds_read_b64_tr_b16 v[156:157], v215 offset:61440
    ds_read_b64_tr_b16 v[158:159], v215 offset:61696
    buffer_load_dwordx4 v228, s[4:7], s40 offen lds
    v_mfma_f32_4x4x4_16b_bf16 v[160:163], a[56:57], v[208:209], v[160:163]
    s_add_u32 s96, s58, s61
    v_mfma_f32_4x4x4_16b_bf16 v[164:167], a[56:57], a[56:57], v[164:167]
    s_add_u32 s58, s58, 1024
    v_mfma_f32_4x4x4_16b_bf16 v[168:171], a[58:59], v[208:209], v[168:171]
    s_and_b32 s58, s58, 0x3c00
    v_mfma_f32_4x4x4_16b_bf16 v[172:175], a[58:59], a[58:59], v[172:175]
    s_add_u32 s97, s58, s61
    s_waitcnt lgkmcnt(4)
    v_mfma_f32_32x32x16_bf16 v[16:31], v[144:147], a[60:63], v[16:31]
    s_add_u32 m0, s46, 33792
    ds_read_b64_tr_b16 v[128:129], v212 offset:0
    ds_read_b64_tr_b16 v[130:131], v212 offset:256
    ds_read_b128 a[64:67], v216 offset:0
    buffer_load_dwordx4 v229, s[4:7], s40 offen lds
    v_mfma_f32_32x32x16_bf16 v[32:47], v[148:151], a[60:63], v[32:47]
    s_add_u32 m0, s46, 34816
    ds_read_b64_tr_b16 v[132:133], v212 offset:4096
    ds_read_b64_tr_b16 v[134:135], v212 offset:4352
    buffer_load_dwordx4 v230, s[4:7], s40 offen lds
    s_waitcnt lgkmcnt(5)
    v_mfma_f32_32x32x16_bf16 v[48:63], v[152:155], a[60:63], v[48:63]
    s_add_u32 m0, s46, 35840
    ds_read_b64_tr_b16 v[136:137], v212 offset:8192
    ds_read_b64_tr_b16 v[138:139], v212 offset:8448
    buffer_load_dwordx4 v231, s[4:7], s40 offen lds
    v_mfma_f32_32x32x16_bf16 v[64:79], v[156:159], a[60:63], v[64:79]
    s_add_u32 m0, s43, 32768
    ds_read_b64_tr_b16 v[140:141], v212 offset:12288
    ds_read_b64_tr_b16 v[142:143], v212 offset:12544
    buffer_load_dwordx4 v220, s[8:11], s41 offen lds
    v_mfma_f32_4x4x4_16b_bf16 v[160:163], a[60:61], v[208:209], v[160:163]
    v_lshlrev_b32 v80, 4, v1
    v_mfma_f32_4x4x4_16b_bf16 v[164:167], a[60:61], a[60:61], v[164:167]
    s_lshr_b32 s58, s36, 1
    v_mfma_f32_4x4x4_16b_bf16 v[168:171], a[62:63], v[208:209], v[168:171]
    s_lshl_b32 s60, s64, 1
    v_mfma_f32_4x4x4_16b_bf16 v[172:175], a[62:63], a[62:63], v[172:175]
    s_add_u32 s59, s60, s58
    s_waitcnt lgkmcnt(4)
    v_mfma_f32_32x32x16_bf16 v[16:31], v[128:131], a[64:67], v[16:31]
    s_add_u32 m0, s43, 36864
    ds_read_b64_tr_b16 v[144:145], v213 offset:0
    ds_read_b64_tr_b16 v[146:147], v213 offset:256
    ds_read_b128 a[68:71], v217 offset:0
    buffer_load_dwordx4 v221, s[8:11], s41 offen lds
    v_mfma_f32_16x16x32_bf16 v[176:179], v[204:207], v[128:131], v[176:179]
    s_xor_b32 s58, s58, 1
    s_add_u32 s58, s60, s58
    v_mfma_f32_32x32x16_bf16 v[32:47], v[132:135], a[64:67], v[32:47]
    s_add_u32 m0, s43, 40960
    ds_read_b64_tr_b16 v[148:149], v213 offset:4096
    ds_read_b64_tr_b16 v[150:151], v213 offset:4352
    buffer_load_dwordx4 v222, s[12:15], s42 offen lds
    v_mfma_f32_16x16x32_bf16 v[180:183], v[204:207], v[132:135], v[180:183]
    s_mul_i32 s60, s59, 114688
    v_add_u32 v234, s60, v80
    s_waitcnt lgkmcnt(5)
    v_mfma_f32_32x32x16_bf16 v[48:63], v[136:139], a[64:67], v[48:63]
    s_add_u32 m0, s43, 45056
    ds_read_b64_tr_b16 v[152:153], v213 offset:8192
    ds_read_b64_tr_b16 v[154:155], v213 offset:8448
    buffer_load_dwordx4 v223, s[12:15], s42 offen lds
    v_mfma_f32_16x16x32_bf16 v[184:187], v[204:207], v[136:139], v[184:187]
    s_mul_i32 s60, s58, 114688
    v_add_u32 v235, s60, v80
    v_mfma_f32_32x32x16_bf16 v[64:79], v[140:143], a[64:67], v[64:79]
    ds_read_b64_tr_b16 v[156:157], v213 offset:12288
    ds_read_b64_tr_b16 v[158:159], v213 offset:12544
    v_mfma_f32_16x16x32_bf16 v[188:191], v[204:207], v[140:143], v[188:191]
    s_lshl_b32 s61, s36, 13
    s_add_u32 s61, s61, 8388608
    v_mfma_f32_4x4x4_16b_bf16 v[160:163], a[64:65], v[208:209], v[160:163]
    s_lshl_b32 s60, s59, 15
    v_mfma_f32_4x4x4_16b_bf16 v[164:167], a[64:65], a[64:65], v[164:167]
    s_add_u32 s60, s60, s61
    v_mfma_f32_4x4x4_16b_bf16 v[168:171], a[66:67], v[208:209], v[168:171]
    v_add_u32 v236, s60, v80
    v_mfma_f32_4x4x4_16b_bf16 v[172:175], a[66:67], a[66:67], v[172:175]
    s_lshl_b32 s60, s58, 15
    s_waitcnt lgkmcnt(4)
    v_mfma_f32_32x32x16_bf16 v[16:31], v[144:147], a[68:71], v[16:31]
    ds_read_b64_tr_b16 v[128:129], v214 offset:0
    ds_read_b64_tr_b16 v[130:131], v214 offset:256
    ds_read_b128 a[72:75], v218 offset:0
    s_add_u32 s60, s60, s61
    v_mfma_f32_32x32x16_bf16 v[32:47], v[148:151], a[68:71], v[32:47]
    ds_read_b64_tr_b16 v[132:133], v214 offset:4096
    ds_read_b64_tr_b16 v[134:135], v214 offset:4352
    v_add_u32 v237, s60, v80
    s_waitcnt lgkmcnt(5)
    v_mfma_f32_32x32x16_bf16 v[48:63], v[152:155], a[68:71], v[48:63]
    ds_read_b64_tr_b16 v[136:137], v214 offset:8192
    ds_read_b64_tr_b16 v[138:139], v214 offset:8448
    s_lshl_b32 s61, s36, 14
    v_mfma_f32_32x32x16_bf16 v[64:79], v[156:159], a[68:71], v[64:79]
    ds_read_b64_tr_b16 v[140:141], v214 offset:12288
    ds_read_b64_tr_b16 v[142:143], v214 offset:12544
    s_add_u32 s61, s61, 13631488
    v_mfma_f32_4x4x4_16b_bf16 v[160:163], a[68:69], v[208:209], v[160:163]
    v_add_u32 v242, s61, v80
    v_mfma_f32_4x4x4_16b_bf16 v[164:167], a[68:69], a[68:69], v[164:167]
    s_lshr_b32 s60, s64, 1
    v_mfma_f32_4x4x4_16b_bf16 v[168:171], a[70:71], v[208:209], v[168:171]
    s_lshl_b32 s60, s60, 2
    v_mfma_f32_4x4x4_16b_bf16 v[172:175], a[70:71], a[70:71], v[172:175]
    s_add_u32 s60, s60, s36
    s_waitcnt lgkmcnt(4)
    v_mfma_f32_32x32x16_bf16 v[16:31], v[128:131], a[72:75], v[16:31]
    ds_read_b64_tr_b16 v[144:145], v215 offset:0
    ds_read_b64_tr_b16 v[146:147], v215 offset:256
    ds_read_b128 a[76:79], v219 offset:0
    v_mfma_f32_32x32x16_bf16 v[32:47], v[132:135], a[72:75], v[32:47]
    ds_read_b64_tr_b16 v[148:149], v215 offset:4096
    ds_read_b64_tr_b16 v[150:151], v215 offset:4352
    s_waitcnt lgkmcnt(5)
    v_mfma_f32_32x32x16_bf16 v[48:63], v[136:139], a[72:75], v[48:63]
    ds_read_b64_tr_b16 v[152:153], v215 offset:8192
    ds_read_b64_tr_b16 v[154:155], v215 offset:8448
    v_mfma_f32_32x32x16_bf16 v[64:79], v[140:143], a[72:75], v[64:79]
    s_waitcnt vmcnt(8)
    s_barrier
    s_add_u32 s39, s39, 0x20000000
    s_lshr_b32 s40, s39, 22
    s_mul_hi_u32 s41, s39, 1572864
    s_mul_hi_u32 s42, s39, 1835008
    s_add_u32 m0, s46, 49152
    ds_read_b64_tr_b16 v[156:157], v215 offset:12288
    ds_read_b64_tr_b16 v[158:159], v215 offset:12544
    buffer_load_dwordx4 v228, s[4:7], s40 offen lds
    v_mfma_f32_4x4x4_16b_bf16 v[160:163], a[72:73], v[208:209], v[160:163]
    s_lshl_b32 s60, s60, 3
    v_mfma_f32_4x4x4_16b_bf16 v[164:167], a[72:73], a[72:73], v[164:167]
    s_and_b32 s61, s64, 1
    v_mfma_f32_4x4x4_16b_bf16 v[168:171], a[74:75], v[208:209], v[168:171]
    s_add_u32 s60, s60, s61
    v_mfma_f32_4x4x4_16b_bf16 v[172:175], a[74:75], a[74:75], v[172:175]
    s_lshl_b32 s60, s60, 8
    s_waitcnt lgkmcnt(4)
    v_mfma_f32_32x32x16_bf16 v[16:31], v[144:147], a[76:79], v[16:31]
    s_add_u32 m0, s46, 50176
    ds_read_b64_tr_b16 v[128:129], v212 offset:16384
    ds_read_b64_tr_b16 v[130:131], v212 offset:16640
    ds_read_b128 a[80:83], v216 offset:16384
    buffer_load_dwordx4 v229, s[4:7], s40 offen lds
    v_mfma_f32_32x32x16_bf16 v[32:47], v[148:151], a[76:79], v[32:47]
    s_add_u32 m0, s46, 51200
    ds_read_b64_tr_b16 v[132:133], v212 offset:20480
    ds_read_b64_tr_b16 v[134:135], v212 offset:20736
    buffer_load_dwordx4 v230, s[4:7], s40 offen lds
    s_waitcnt lgkmcnt(5)
    v_mfma_f32_32x32x16_bf16 v[48:63], v[152:155], a[76:79], v[48:63]
    s_add_u32 m0, s46, 52224
    ds_read_b64_tr_b16 v[136:137], v212 offset:24576
    ds_read_b64_tr_b16 v[138:139], v212 offset:24832
    buffer_load_dwordx4 v231, s[4:7], s40 offen lds
    v_mfma_f32_32x32x16_bf16 v[64:79], v[156:159], a[76:79], v[64:79]
    s_add_u32 m0, s43, 49152
    ds_read_b64_tr_b16 v[140:141], v212 offset:28672
    ds_read_b64_tr_b16 v[142:143], v212 offset:28928
    buffer_load_dwordx4 v220, s[8:11], s41 offen lds
    v_mfma_f32_4x4x4_16b_bf16 v[160:163], a[76:77], v[208:209], v[160:163]
    s_add_u32 s60, s60, 14680064
    v_mfma_f32_4x4x4_16b_bf16 v[164:167], a[76:77], a[76:77], v[164:167]
    v_bfe_u32 v81, v1, 1, 2
    v_mfma_f32_4x4x4_16b_bf16 v[168:171], a[78:79], v[208:209], v[168:171]
    v_lshlrev_b32 v81, 9, v81
    v_mfma_f32_4x4x4_16b_bf16 v[172:175], a[78:79], a[78:79], v[172:175]
    v_and_b32 v82, 1, v1
    s_waitcnt lgkmcnt(4)
    v_mfma_f32_32x32x16_bf16 v[16:31], v[128:131], a[80:83], v[16:31]
    s_add_u32 m0, s43, 53248
    ds_read_b64_tr_b16 v[144:145], v213 offset:16384
    ds_read_b64_tr_b16 v[146:147], v213 offset:16640
    ds_read_b128 a[84:87], v217 offset:16384
    buffer_load_dwordx4 v221, s[8:11], s41 offen lds
    v_mfma_f32_16x16x32_bf16 v[176:179], v[204:207], v[128:131], v[176:179]
    v_lshl_add_u32 v81, v82, 7, v81
    v_add_u32 v240, s60, v81
    v_mfma_f32_32x32x16_bf16 v[32:47], v[132:135], a[80:83], v[32:47]
    s_add_u32 m0, s43, 57344
    ds_read_b64_tr_b16 v[148:149], v213 offset:20480
    ds_read_b64_tr_b16 v[150:151], v213 offset:20736
    buffer_load_dwordx4 v222, s[12:15], s42 offen lds
    v_mfma_f32_16x16x32_bf16 v[180:183], v[204:207], v[132:135], v[180:183]
    v_or_b32 v81, 512, v81
    s_add_u32 s60, s60, 262144
    s_waitcnt lgkmcnt(5)
    v_mfma_f32_32x32x16_bf16 v[48:63], v[136:139], a[80:83], v[48:63]
    s_add_u32 m0, s43, 61440
    ds_read_b64_tr_b16 v[152:153], v213 offset:24576
    ds_read_b64_tr_b16 v[154:155], v213 offset:24832
    buffer_load_dwordx4 v223, s[12:15], s42 offen lds
    v_mfma_f32_16x16x32_bf16 v[184:187], v[204:207], v[136:139], v[184:187]
    v_add_u32 v233, s60, v81
    s_lshl_b32 s60, s36, 6
    v_mfma_f32_32x32x16_bf16 v[64:79], v[140:143], a[80:83], v[64:79]
    ds_read_b64_tr_b16 v[156:157], v213 offset:28672
    ds_read_b64_tr_b16 v[158:159], v213 offset:28928
    v_mfma_f32_16x16x32_bf16 v[188:191], v[204:207], v[140:143], v[188:191]
    s_and_b32 s61, s2, 31
    s_add_u32 s60, s60, s61
    v_mfma_f32_4x4x4_16b_bf16 v[160:163], a[80:81], v[208:209], v[160:163]
    s_lshl_b32 s60, s60, 7
    v_mfma_f32_4x4x4_16b_bf16 v[164:167], a[80:81], a[80:81], v[164:167]
    s_add_u32 s60, s60, 14876672
    v_mfma_f32_4x4x4_16b_bf16 v[168:171], a[82:83], v[208:209], v[168:171]
    v_lshl_add_u32 v241, v82, 12, s60
    v_mfma_f32_4x4x4_16b_bf16 v[172:175], a[82:83], a[82:83], v[172:175]
    s_lshl_b32 s60, s59, 15
    s_waitcnt lgkmcnt(4)
    v_mfma_f32_32x32x16_bf16 v[16:31], v[144:147], a[84:87], v[16:31]
    ds_read_b64_tr_b16 v[128:129], v214 offset:16384
    ds_read_b64_tr_b16 v[130:131], v214 offset:16640
    ds_read_b128 a[88:91], v218 offset:16384
    s_lshl_b32 s61, s65, 7
    v_mfma_f32_32x32x16_bf16 v[32:47], v[148:151], a[84:87], v[32:47]
    ds_read_b64_tr_b16 v[132:133], v214 offset:20480
    ds_read_b64_tr_b16 v[134:135], v214 offset:20736
    s_add_u32 s60, s60, s61
    s_waitcnt lgkmcnt(5)
    v_mfma_f32_32x32x16_bf16 v[48:63], v[152:155], a[84:87], v[48:63]
    ds_read_b64_tr_b16 v[136:137], v214 offset:24576
    ds_read_b64_tr_b16 v[138:139], v214 offset:24832
    s_and_b32 s61, s36, 1
    v_mfma_f32_32x32x16_bf16 v[64:79], v[156:159], a[84:87], v[64:79]
    ds_read_b64_tr_b16 v[140:141], v214 offset:28672
    ds_read_b64_tr_b16 v[142:143], v214 offset:28928
    s_lshl_b32 s61, s61, 6
    v_mfma_f32_4x4x4_16b_bf16 v[160:163], a[84:85], v[208:209], v[160:163]
    s_add_u32 s60, s60, s61
    v_mfma_f32_4x4x4_16b_bf16 v[164:167], a[84:85], a[84:85], v[164:167]
    v_lshrrev_b32 v80, 5, v1
    v_mfma_f32_4x4x4_16b_bf16 v[168:171], a[86:87], v[208:209], v[168:171]
    v_and_b32 v81, 31, v1
    v_mfma_f32_4x4x4_16b_bf16 v[172:175], a[86:87], a[86:87], v[172:175]
    v_lshlrev_b32 v82, 10, v81
    s_waitcnt lgkmcnt(4)
    v_mfma_f32_32x32x16_bf16 v[16:31], v[128:131], a[88:91], v[16:31]
    ds_read_b64_tr_b16 v[144:145], v215 offset:16384
    ds_read_b64_tr_b16 v[146:147], v215 offset:16640
    ds_read_b128 a[92:95], v219 offset:16384
    v_mfma_f32_32x32x16_bf16 v[32:47], v[132:135], a[88:91], v[32:47]
    ds_read_b64_tr_b16 v[148:149], v215 offset:20480
    ds_read_b64_tr_b16 v[150:151], v215 offset:20736
    s_waitcnt lgkmcnt(5)
    v_mfma_f32_32x32x16_bf16 v[48:63], v[136:139], a[88:91], v[48:63]
    ds_read_b64_tr_b16 v[152:153], v215 offset:24576
    ds_read_b64_tr_b16 v[154:155], v215 offset:24832
    v_mfma_f32_32x32x16_bf16 v[64:79], v[140:143], a[88:91], v[64:79]
    s_waitcnt vmcnt(8)
    s_barrier
    s_add_u32 s39, s39, 0x20000000
    s_mul_hi_u32 s42, s39, 1835008
    s_add_u32 m0, s43, 0
    ds_read_b64_tr_b16 v[156:157], v215 offset:28672
    ds_read_b64_tr_b16 v[158:159], v215 offset:28928
    buffer_load_dwordx4 v224, s[12:15], s42 offen lds
    v_mfma_f32_4x4x4_16b_bf16 v[160:163], a[88:89], v[208:209], v[160:163]
    s_lshl_b32 s41, s37, 4
    v_mfma_f32_4x4x4_16b_bf16 v[164:167], a[88:89], a[88:89], v[164:167]
    s_lshl_b32 s40, s38, 1
    v_mfma_f32_4x4x4_16b_bf16 v[168:171], a[90:91], v[208:209], v[168:171]
    s_add_u32 s41, s41, s40
    v_mfma_f32_4x4x4_16b_bf16 v[172:175], a[90:91], a[90:91], v[172:175]
    s_add_u32 s41, s41, 1
    s_waitcnt lgkmcnt(4)
    v_mfma_f32_32x32x16_bf16 v[16:31], v[144:147], a[92:95], v[16:31]
    s_add_u32 s39, s39, 0x20000000
    s_mul_hi_u32 s42, s39, 1835008
    s_add_u32 m0, s43, 4096
    ds_read_b64_tr_b16 v[128:129], v212 offset:32768
    ds_read_b64_tr_b16 v[130:131], v212 offset:33024
    ds_read_b128 a[96:99], v216 offset:32768
    buffer_load_dwordx4 v224, s[12:15], s42 offen lds
    v_mfma_f32_32x32x16_bf16 v[32:47], v[148:151], a[92:95], v[32:47]
    s_add_u32 s39, s39, 0x20000000
    s_mul_hi_u32 s42, s39, 1835008
    s_add_u32 m0, s43, 8192
    ds_read_b64_tr_b16 v[132:133], v212 offset:36864
    ds_read_b64_tr_b16 v[134:135], v212 offset:37120
    buffer_load_dwordx4 v224, s[12:15], s42 offen lds
    s_waitcnt lgkmcnt(5)
    v_mfma_f32_32x32x16_bf16 v[48:63], v[152:155], a[92:95], v[48:63]
    ds_read_b64_tr_b16 v[136:137], v212 offset:40960
    ds_read_b64_tr_b16 v[138:139], v212 offset:41216
    v_mfma_f32_32x32x16_bf16 v[64:79], v[156:159], a[92:95], v[64:79]
    ds_read_b64_tr_b16 v[140:141], v212 offset:45056
    ds_read_b64_tr_b16 v[142:143], v212 offset:45312
    v_mfma_f32_4x4x4_16b_bf16 v[160:163], a[92:93], v[208:209], v[160:163]
    s_lshl_b32 s41, s41, 2
    v_mfma_f32_4x4x4_16b_bf16 v[164:167], a[92:93], a[92:93], v[164:167]
    s_add_u32 s41, s41, s36
    v_mfma_f32_4x4x4_16b_bf16 v[168:171], a[94:95], v[208:209], v[168:171]
    s_lshl_b32 s41, s41, 7
    v_mfma_f32_4x4x4_16b_bf16 v[172:175], a[94:95], a[94:95], v[172:175]
    s_add_u32 s40, s41, 262144
    s_waitcnt lgkmcnt(4)
    v_mfma_f32_32x32x16_bf16 v[16:31], v[128:131], a[96:99], v[16:31]
    ds_read_b64_tr_b16 v[144:145], v213 offset:32768
    ds_read_b64_tr_b16 v[146:147], v213 offset:33024
    ds_read_b128 a[100:103], v217 offset:32768
    v_mfma_f32_16x16x32_bf16 v[176:179], v[204:207], v[128:131], v[176:179]
    v_readfirstlane_b32 s44, v250
    v_readfirstlane_b32 s45, v251
    s_cmp_lg_u32 s44, 0
    s_cbranch_scc1 nond_10
    s_mov_b32 s67, 0x8000
non_9:
    buffer_load_dwordx2 v[250:251], v243, s[32:35], 0 offen sc1
    s_waitcnt vmcnt(0)
    v_readfirstlane_b32 s44, v250
    v_readfirstlane_b32 s45, v251
    s_cmp_lg_u32 s44, 0
    s_cbranch_scc1 nond_10
    s_sub_u32 s67, s67, 1
    s_cmp_lg_u32 s67, 0
    s_cbranch_scc1 non_9
nond_10:
    v_lshl_add_u32 v82, v80, 3, v82
    v_add_u32 v239, s60, v82
    v_mfma_f32_32x32x16_bf16 v[32:47], v[132:135], a[96:99], v[32:47]
    ds_read_b64_tr_b16 v[148:149], v213 offset:36864
    ds_read_b64_tr_b16 v[150:151], v213 offset:37120
    v_mfma_f32_16x16x32_bf16 v[180:183], v[204:207], v[132:135], v[180:183]
    s_lshl_b32 s60, s59, 7
    s_lshl_b32 s61, s36, 14
    s_waitcnt lgkmcnt(5)
    v_mfma_f32_32x32x16_bf16 v[48:63], v[136:139], a[96:99], v[48:63]
    ds_read_b64_tr_b16 v[152:153], v213 offset:40960
    ds_read_b64_tr_b16 v[154:155], v213 offset:41216
    v_mfma_f32_16x16x32_bf16 v[184:187], v[204:207], v[136:139], v[184:187]
    s_add_u32 s60, s60, s61
    s_add_u32 s60, s60, 13697024
    v_mfma_f32_32x32x16_bf16 v[64:79], v[140:143], a[96:99], v[64:79]
    ds_read_b64_tr_b16 v[156:157], v213 offset:45056
    ds_read_b64_tr_b16 v[158:159], v213 offset:45312
    v_mfma_f32_16x16x32_bf16 v[188:191], v[204:207], v[140:143], v[188:191]
    v_lshlrev_b32 v81, 2, v81
    v_add_u32 v253, s60, v81
    v_mfma_f32_4x4x4_16b_bf16 v[160:163], a[96:97], v[208:209], v[160:163]
    v_mfma_f32_4x4x4_16b_bf16 v[164:167], a[96:97], a[96:97], v[164:167]
    v_mfma_f32_4x4x4_16b_bf16 v[168:171], a[98:99], v[208:209], v[168:171]
    v_mfma_f32_4x4x4_16b_bf16 v[172:175], a[98:99], a[98:99], v[172:175]
    s_waitcnt lgkmcnt(4)
    v_mfma_f32_32x32x16_bf16 v[16:31], v[144:147], a[100:103], v[16:31]
    ds_read_b64_tr_b16 v[128:129], v214 offset:32768
    ds_read_b64_tr_b16 v[130:131], v214 offset:33024
    ds_read_b128 a[104:107], v218 offset:32768
    v_mfma_f32_32x32x16_bf16 v[32:47], v[148:151], a[100:103], v[32:47]
    ds_read_b64_tr_b16 v[132:133], v214 offset:36864
    ds_read_b64_tr_b16 v[134:135], v214 offset:37120
    s_waitcnt lgkmcnt(5)
    v_mfma_f32_32x32x16_bf16 v[48:63], v[152:155], a[100:103], v[48:63]
    ds_read_b64_tr_b16 v[136:137], v214 offset:40960
    ds_read_b64_tr_b16 v[138:139], v214 offset:41216
    v_mfma_f32_32x32x16_bf16 v[64:79], v[156:159], a[100:103], v[64:79]
    ds_read_b64_tr_b16 v[140:141], v214 offset:45056
    ds_read_b64_tr_b16 v[142:143], v214 offset:45312
    v_mfma_f32_4x4x4_16b_bf16 v[160:163], a[100:101], v[208:209], v[160:163]
    v_mfma_f32_4x4x4_16b_bf16 v[164:167], a[100:101], a[100:101], v[164:167]
    v_mfma_f32_4x4x4_16b_bf16 v[168:171], a[102:103], v[208:209], v[168:171]
    v_mfma_f32_4x4x4_16b_bf16 v[172:175], a[102:103], a[102:103], v[172:175]
    s_waitcnt lgkmcnt(4)
    v_mfma_f32_32x32x16_bf16 v[16:31], v[128:131], a[104:107], v[16:31]
    ds_read_b64_tr_b16 v[144:145], v215 offset:32768
    ds_read_b64_tr_b16 v[146:147], v215 offset:33024
    ds_read_b128 a[108:111], v219 offset:32768
    v_mfma_f32_32x32x16_bf16 v[32:47], v[132:135], a[104:107], v[32:47]
    ds_read_b64_tr_b16 v[148:149], v215 offset:36864
    ds_read_b64_tr_b16 v[150:151], v215 offset:37120
    s_waitcnt lgkmcnt(5)
    v_mfma_f32_32x32x16_bf16 v[48:63], v[136:139], a[104:107], v[48:63]
    ds_read_b64_tr_b16 v[152:153], v215 offset:40960
    ds_read_b64_tr_b16 v[154:155], v215 offset:41216
    v_mfma_f32_32x32x16_bf16 v[64:79], v[140:143], a[104:107], v[64:79]
    s_waitcnt vmcnt(3)
    s_barrier
    s_add_u32 s39, s39, 0x20000000
    s_mul_hi_u32 s42, s39, 1835008
    s_add_u32 m0, s43, 16384
    ds_read_b64_tr_b16 v[156:157], v215 offset:45056
    ds_read_b64_tr_b16 v[158:159], v215 offset:45312
    buffer_load_dwordx4 v224, s[12:15], s42 offen lds
    v_mfma_f32_4x4x4_16b_bf16 v[160:163], a[104:105], v[208:209], v[160:163]
    v_mfma_f32_4x4x4_16b_bf16 v[164:167], a[104:105], a[104:105], v[164:167]
    v_mfma_f32_4x4x4_16b_bf16 v[168:171], a[106:107], v[208:209], v[168:171]
    v_mfma_f32_4x4x4_16b_bf16 v[172:175], a[106:107], a[106:107], v[172:175]
    s_waitcnt lgkmcnt(4)
    v_mfma_f32_32x32x16_bf16 v[16:31], v[144:147], a[108:111], v[16:31]
    s_add_u32 s39, s39, 0x20000000
    s_mul_hi_u32 s42, s39, 1835008
    s_add_u32 m0, s43, 20480
    ds_read_b64_tr_b16 v[128:129], v212 offset:49152
    ds_read_b64_tr_b16 v[130:131], v212 offset:49408
    ds_read_b128 a[112:115], v216 offset:49152
    buffer_load_dwordx4 v224, s[12:15], s42 offen lds
    v_mfma_f32_32x32x16_bf16 v[32:47], v[148:151], a[108:111], v[32:47]
    s_add_u32 s39, s39, 0x20000000
    s_mul_hi_u32 s42, s39, 1835008
    s_add_u32 m0, s43, 24576
    ds_read_b64_tr_b16 v[132:133], v212 offset:53248
    ds_read_b64_tr_b16 v[134:135], v212 offset:53504
    buffer_load_dwordx4 v224, s[12:15], s42 offen lds
    s_waitcnt lgkmcnt(5)
    v_mfma_f32_32x32x16_bf16 v[48:63], v[152:155], a[108:111], v[48:63]
    ds_read_b64_tr_b16 v[136:137], v212 offset:57344
    ds_read_b64_tr_b16 v[138:139], v212 offset:57600
    v_mfma_f32_32x32x16_bf16 v[64:79], v[156:159], a[108:111], v[64:79]
    ds_read_b64_tr_b16 v[140:141], v212 offset:61440
    ds_read_b64_tr_b16 v[142:143], v212 offset:61696
    v_mfma_f32_4x4x4_16b_bf16 v[160:163], a[108:109], v[208:209], v[160:163]
    v_mfma_f32_4x4x4_16b_bf16 v[164:167], a[108:109], a[108:109], v[164:167]
    v_mfma_f32_4x4x4_16b_bf16 v[168:171], a[110:111], v[208:209], v[168:171]
    v_mfma_f32_4x4x4_16b_bf16 v[172:175], a[110:111], a[110:111], v[172:175]
    s_waitcnt lgkmcnt(4)
    v_mfma_f32_32x32x16_bf16 v[16:31], v[128:131], a[112:115], v[16:31]
    ds_read_b64_tr_b16 v[144:145], v213 offset:49152
    ds_read_b64_tr_b16 v[146:147], v213 offset:49408
    ds_read_b128 a[116:119], v217 offset:49152
    v_mfma_f32_16x16x32_bf16 v[176:179], v[204:207], v[128:131], v[176:179]
    v_mfma_f32_32x32x16_bf16 v[32:47], v[132:135], a[112:115], v[32:47]
    ds_read_b64_tr_b16 v[148:149], v213 offset:53248
    ds_read_b64_tr_b16 v[150:151], v213 offset:53504
    v_mfma_f32_16x16x32_bf16 v[180:183], v[204:207], v[132:135], v[180:183]
    s_waitcnt lgkmcnt(5)
    v_mfma_f32_32x32x16_bf16 v[48:63], v[136:139], a[112:115], v[48:63]
    ds_read_b64_tr_b16 v[152:153], v213 offset:57344
    ds_read_b64_tr_b16 v[154:155], v213 offset:57600
    v_mfma_f32_16x16x32_bf16 v[184:187], v[204:207], v[136:139], v[184:187]
    v_mfma_f32_32x32x16_bf16 v[64:79], v[140:143], a[112:115], v[64:79]
    ds_read_b64_tr_b16 v[156:157], v213 offset:61440
    ds_read_b64_tr_b16 v[158:159], v213 offset:61696
    v_mfma_f32_16x16x32_bf16 v[188:191], v[204:207], v[140:143], v[188:191]
    v_mfma_f32_4x4x4_16b_bf16 v[160:163], a[112:113], v[208:209], v[160:163]
    v_mfma_f32_4x4x4_16b_bf16 v[164:167], a[112:113], a[112:113], v[164:167]
    v_mfma_f32_4x4x4_16b_bf16 v[168:171], a[114:115], v[208:209], v[168:171]
    v_mfma_f32_4x4x4_16b_bf16 v[172:175], a[114:115], a[114:115], v[172:175]
    s_waitcnt lgkmcnt(4)
    v_mfma_f32_32x32x16_bf16 v[16:31], v[144:147], a[116:119], v[16:31]
    ds_read_b64_tr_b16 v[128:129], v214 offset:49152
    ds_read_b64_tr_b16 v[130:131], v214 offset:49408
    ds_read_b128 a[120:123], v218 offset:49152
    v_mfma_f32_32x32x16_bf16 v[32:47], v[148:151], a[116:119], v[32:47]
    ds_read_b64_tr_b16 v[132:133], v214 offset:53248
    ds_read_b64_tr_b16 v[134:135], v214 offset:53504
    v_cvt_pk_bf16_f32 v177, v176, v176
    v_cvt_pk_bf16_f32 v181, v180, v180
    s_waitcnt lgkmcnt(5)
    v_mfma_f32_32x32x16_bf16 v[48:63], v[152:155], a[116:119], v[48:63]
    ds_read_b64_tr_b16 v[136:137], v214 offset:57344
    ds_read_b64_tr_b16 v[138:139], v214 offset:57600
    v_cvt_pk_bf16_f32 v185, v184, v184
    v_cvt_pk_bf16_f32 v189, v188, v188
    v_mfma_f32_32x32x16_bf16 v[64:79], v[156:159], a[116:119], v[64:79]
    ds_read_b64_tr_b16 v[140:141], v214 offset:61440
    ds_read_b64_tr_b16 v[142:143], v214 offset:61696
    v_and_b32 v177, s69, v177
    v_and_b32 v181, s69, v181
    v_mfma_f32_4x4x4_16b_bf16 v[160:163], a[116:117], v[208:209], v[160:163]
    v_mfma_f32_4x4x4_16b_bf16 v[164:167], a[116:117], a[116:117], v[164:167]
    v_mfma_f32_4x4x4_16b_bf16 v[168:171], a[118:119], v[208:209], v[168:171]
    v_mfma_f32_4x4x4_16b_bf16 v[172:175], a[118:119], a[118:119], v[172:175]
    s_waitcnt lgkmcnt(4)
    v_mfma_f32_32x32x16_bf16 v[16:31], v[128:131], a[120:123], v[16:31]
    s_waitcnt vmcnt(3)
    s_barrier
    s_add_u32 s39, s39, 0x20000000
    s_mul_hi_u32 s42, s39, 1835008
    s_add_u32 m0, s43, 32768
    ds_read_b64_tr_b16 v[144:145], v215 offset:49152
    ds_read_b64_tr_b16 v[146:147], v215 offset:49408
    ds_read_b128 a[124:127], v219 offset:49152
    buffer_load_dwordx4 v224, s[12:15], s42 offen lds
    v_and_b32 v185, s69, v185
    v_and_b32 v189, s69, v189
    v_mfma_f32_32x32x16_bf16 v[32:47], v[132:135], a[120:123], v[32:47]
    s_add_u32 s39, s39, 0x20000000
    s_mul_hi_u32 s42, s39, 1835008
    s_add_u32 m0, s43, 36864
    ds_read_b64_tr_b16 v[148:149], v215 offset:53248
    ds_read_b64_tr_b16 v[150:151], v215 offset:53504
    buffer_load_dwordx4 v224, s[12:15], s42 offen lds
    v_sub_f32 v177, v176, v177
    v_sub_f32 v181, v180, v181
    s_waitcnt lgkmcnt(5)
    v_mfma_f32_32x32x16_bf16 v[48:63], v[136:139], a[120:123], v[48:63]
    s_add_u32 s39, s39, 0x20000000
    s_mul_hi_u32 s42, s39, 1835008
    s_add_u32 m0, s43, 40960
    ds_read_b64_tr_b16 v[152:153], v215 offset:57344
    ds_read_b64_tr_b16 v[154:155], v215 offset:57600
    buffer_load_dwordx4 v225, s[12:15], s42 offen lds
    v_sub_f32 v185, v184, v185
    v_sub_f32 v189, v188, v189
    v_mfma_f32_32x32x16_bf16 v[64:79], v[140:143], a[120:123], v[64:79]
    ds_read_b64_tr_b16 v[156:157], v215 offset:61440
    ds_read_b64_tr_b16 v[158:159], v215 offset:61696
    v_cvt_pk_bf16_f32 v176, v176, v177
    v_cvt_pk_bf16_f32 v180, v180, v181
    v_mfma_f32_4x4x4_16b_bf16 v[160:163], a[120:121], v[208:209], v[160:163]
    v_mfma_f32_4x4x4_16b_bf16 v[164:167], a[120:121], a[120:121], v[164:167]
    v_mfma_f32_4x4x4_16b_bf16 v[168:171], a[122:123], v[208:209], v[168:171]
    v_mfma_f32_4x4x4_16b_bf16 v[172:175], a[122:123], a[122:123], v[172:175]
    s_waitcnt lgkmcnt(4)
    v_mfma_f32_32x32x16_bf16 v[16:31], v[144:147], a[124:127], v[16:31]
    ds_read_b64_tr_b16 v[128:129], v212 offset:0
    ds_read_b64_tr_b16 v[130:131], v212 offset:256
    v_cvt_pk_bf16_f32 v184, v184, v185
    v_cvt_pk_bf16_f32 v188, v188, v189
    v_mfma_f32_32x32x16_bf16 v[32:47], v[148:151], a[124:127], v[32:47]
    ds_read_b64_tr_b16 v[132:133], v212 offset:4096
    ds_read_b64_tr_b16 v[134:135], v212 offset:4352
    ds_write_b32 v3, v176 offset:0
    ds_write_b32 v3, v180 offset:512
    s_waitcnt lgkmcnt(6)
    v_mfma_f32_32x32x16_bf16 v[48:63], v[152:155], a[124:127], v[48:63]
    ds_read_b64_tr_b16 v[136:137], v212 offset:8192
    ds_read_b64_tr_b16 v[138:139], v212 offset:8448
    ds_write_b32 v3, v184 offset:1024
    ds_write_b32 v3, v188 offset:1536
    v_mfma_f32_32x32x16_bf16 v[64:79], v[156:159], a[124:127], v[64:79]
    v_mfma_f32_4x4x4_16b_bf16 v[160:163], a[124:125], v[208:209], v[160:163]
    v_mfma_f32_4x4x4_16b_bf16 v[164:167], a[124:125], a[124:125], v[164:167]
    v_mfma_f32_4x4x4_16b_bf16 v[168:171], a[126:127], v[208:209], v[168:171]
    v_mfma_f32_4x4x4_16b_bf16 v[172:175], a[126:127], a[126:127], v[172:175]
    s_waitcnt lgkmcnt(6)
    v_mfma_f32_32x32x16_bf16 v[80:95], v[128:131], a[0:3], 0
    ds_read_b64_tr_b16 v[140:141], v213 offset:0
    ds_read_b64_tr_b16 v[142:143], v213 offset:256
    v_mfma_f32_16x16x32_bf16 v[192:195], v[204:207], v[128:131], 0
    v_mfma_f32_32x32x16_bf16 v[80:95], v[132:135], a[16:19], v[80:95]
    ds_read_b64_tr_b16 v[144:145], v213 offset:4096
    ds_read_b64_tr_b16 v[146:147], v213 offset:4352
    v_mfma_f32_16x16x32_bf16 v[192:195], v[204:207], v[132:135], v[192:195]
    v_pk_add_f32 v[160:161], v[160:161], v[168:169]
    v_pk_add_f32 v[164:165], v[164:165], v[172:173]
    v_pk_add_f32 v[162:163], v[162:163], v[170:171]
    v_pk_add_f32 v[166:167], v[166:167], v[174:175]
    s_mov_b32 s56, 0x22222222
    s_mov_b32 s57, 0x22222222
    s_mov_b32 s58, 0x44444444
    s_mov_b32 s59, 0x44444444
    s_mov_b32 s60, 0x88888888
    s_waitcnt lgkmcnt(6)
    v_mfma_f32_32x32x16_bf16 v[80:95], v[136:139], a[32:35], v[80:95]
    ds_read_b64_tr_b16 v[148:149], v213 offset:8192
    ds_read_b64_tr_b16 v[150:151], v213 offset:8448
    v_mfma_f32_16x16x32_bf16 v[192:195], v[204:207], v[136:139], v[192:195]
    s_mov_b32 s61, 0x88888888
    v_cndmask_b32 v160, v160, v161, s[56:57]
    v_cndmask_b32 v164, v164, v165, s[56:57]
    v_cndmask_b32 v160, v160, v162, s[58:59]
    v_cndmask_b32 v164, v164, v166, s[58:59]
    v_cndmask_b32 v160, v160, v163, s[60:61]
    v_cndmask_b32 v164, v164, v167, s[60:61]
    v_mov_b32 v168, v160
    s_waitcnt lgkmcnt(2)
    v_mfma_f32_32x32x16_bf16 v[80:95], v[140:143], a[4:7], v[80:95]
    ds_read_b64_tr_b16 v[128:129], v214 offset:0
    ds_read_b64_tr_b16 v[130:131], v214 offset:256
    v_mov_b32 v172, v164
    s_nop 0
    s_nop 0
    v_permlane32_swap_b32 v160, v168
    v_permlane32_swap_b32 v164, v172
    s_nop 0
    v_add_f32 v160, v160, v168
    v_add_f32 v164, v164, v172
    v_mfma_f32_32x32x16_bf16 v[80:95], v[144:147], a[20:23], v[80:95]
    ds_read_b64_tr_b16 v[132:133], v214 offset:4096
    ds_read_b64_tr_b16 v[134:135], v214 offset:4352
    v_mul_f32 v160, 0x3b000000, v160
    v_mul_f32 v164, 0x3b000000, v164
    v_fma_f32 v164, -v160, v160, v164
    v_max_f32 v164, 0, v164
    v_cvt_pk_bf16_f32 v160, v160, v160
    v_and_b32 v160, s69, v160
    v_cvt_pk_bf16_f32 v164, v164, v164
    v_and_b32 v164, s69, v164
    s_waitcnt lgkmcnt(4)
    v_mfma_f32_32x32x16_bf16 v[80:95], v[148:151], a[36:39], v[80:95]
    ds_read_b64_tr_b16 v[136:137], v214 offset:8192
    ds_read_b64_tr_b16 v[138:139], v214 offset:8448
    v_add_f32 v164, 0x3727c5ac, v164
    v_cvt_pk_bf16_f32 v164, v164, v164
    v_and_b32 v164, s69, v164
    v_sqrt_f32 v164, v164
    s_nop 0
    v_cvt_pk_bf16_f32 v164, v164, v164
    v_and_b32 v164, s69, v164
    v_rcp_f32 v2, v164
    s_waitcnt lgkmcnt(2)
    v_mfma_f32_32x32x16_bf16 v[80:95], v[128:131], a[8:11], v[80:95]
    s_waitcnt vmcnt(3)
    s_barrier
    s_add_u32 m0, s43, 49152
    ds_read_b64_tr_b16 v[140:141], v215 offset:0
    ds_read_b64_tr_b16 v[142:143], v215 offset:256
    buffer_load_dwordx4 v226, s[12:15], s42 offen lds
    v_xor_b32 v160, 0x80000000, v160
    v_cvt_pk_bf16_f32 v8, v160, v160
    v_cndmask_b32 v8, 0, v8, s[100:101]
    v_mov_b32 v9, v8
    v_mov_b32 v10, v8
    v_mov_b32 v11, v8
    v_mul_f32 v174, 0x3fb8aa3b, v2
    s_lshl_b32 s56, s37, 2
    s_add_u32 s56, s56, s36
    s_lshl_b32 s56, s56, 7
    s_lshl_b32 s57, s38, 13
    s_add_u32 s56, s56, s57
    v_and_b32 v232, 31, v1
    v_lshlrev_b32 v232, 2, v232
    v_add_u32 v232, 13697024, v232
    buffer_store_dword v2, v232, s[28:31], s56 offen sc1
    v_mfma_f32_32x32x16_bf16 v[80:95], v[132:135], a[24:27], v[80:95]
    s_add_u32 s39, s39, 0x20000000
    s_mul_hi_u32 s42, s39, 1835008
    s_add_u32 m0, s43, 53248
    ds_read_b64_tr_b16 v[144:145], v215 offset:4096
    ds_read_b64_tr_b16 v[146:147], v215 offset:4352
    buffer_load_dwordx4 v225, s[12:15], s42 offen lds
    ds_read_b128 v[176:179], v6 offset:0
    ds_read_b128 v[180:183], v6 offset:512
    ds_read_b128 v[184:187], v6 offset:1024
    ds_read_b128 v[188:191], v6 offset:1536
    s_waitcnt lgkmcnt(3)
    v_mfma_f32_32x32x16_bf16 v[16:31], v[176:179], v[8:11], v[16:31]
    v_mfma_f32_32x32x16_bf16 v[80:95], v[136:139], a[40:43], v[80:95]
    s_add_u32 m0, s43, 57344
    ds_read_b64_tr_b16 v[148:149], v215 offset:8192
    ds_read_b64_tr_b16 v[150:151], v215 offset:8448
    buffer_load_dwordx4 v226, s[12:15], s42 offen lds
    s_waitcnt lgkmcnt(4)
    v_mfma_f32_32x32x16_bf16 v[32:47], v[180:183], v[8:11], v[32:47]
    s_waitcnt lgkmcnt(3)
    v_mfma_f32_32x32x16_bf16 v[48:63], v[184:187], v[8:11], v[48:63]
    s_waitcnt lgkmcnt(2)
    v_mfma_f32_32x32x16_bf16 v[80:95], v[140:143], a[12:15], v[80:95]
    s_lshl_b32 s62, s70, 4
    s_add_u32 m0, s3, 0
    ds_read_b64_tr_b16 v[128:129], v212 offset:16384
    ds_read_b64_tr_b16 v[130:131], v212 offset:16640
    buffer_load_dwordx4 v254, s[16:19], s62 offen lds
    v_mfma_f32_32x32x16_bf16 v[64:79], v[188:191], v[8:11], v[64:79]
    s_nop 11
    v_pk_mul_f32 v[16:17], v[16:17], v[174:175] op_sel_hi:[1,0]
    v_pk_mul_f32 v[18:19], v[18:19], v[174:175] op_sel_hi:[1,0]
    v_exp_f32 v248, v16 clamp
    v_mfma_f32_32x32x16_bf16 v[80:95], v[144:147], a[28:31], v[80:95]
    s_add_u32 m0, s3, 1024
    ds_read_b64_tr_b16 v[132:133], v212 offset:20480
    ds_read_b64_tr_b16 v[134:135], v212 offset:20736
    buffer_load_dwordx4 v255, s[16:19], s62 offen lds
    v_exp_f32 v249, v17 clamp
    v_exp_f32 v250, v18 clamp
    v_exp_f32 v251, v19 clamp
    v_max_f32 v16, 0, v16
    v_max_f32 v17, 0, v17
    s_waitcnt lgkmcnt(4)
    v_mfma_f32_32x32x16_bf16 v[80:95], v[148:151], a[44:47], v[80:95]
    s_lshl_b32 s62, s71, 4
    s_add_u32 m0, s3, 2048
    ds_read_b64_tr_b16 v[136:137], v212 offset:24576
    ds_read_b64_tr_b16 v[138:139], v212 offset:24832
    buffer_load_dwordx4 v254, s[16:19], s62 offen lds
    v_max_f32 v18, 0, v18
    v_max_f32 v19, 0, v19
    v_pk_add_f32 v[248:249], v[248:249], s[66:67] op_sel_hi:[1,0]
    v_pk_add_f32 v[250:251], v[250:251], s[66:67] op_sel_hi:[1,0]
    v_pk_fma_f32 v[16:17], v[16:17], s[68:69], v[248:249] op_sel_hi:[1,0,1]
    s_waitcnt lgkmcnt(2)
    v_mfma_f32_32x32x16_bf16 v[80:95], v[128:131], a[48:51], v[80:95]
    s_add_u32 m0, s3, 3072
    ds_read_b64_tr_b16 v[140:141], v213 offset:16384
    ds_read_b64_tr_b16 v[142:143], v213 offset:16640
    buffer_load_dwordx4 v255, s[16:19], s62 offen lds
    v_mfma_f32_16x16x32_bf16 v[192:195], v[204:207], v[128:131], v[192:195]
    v_pk_fma_f32 v[18:19], v[18:19], s[68:69], v[250:251] op_sel_hi:[1,0,1]
    v_cvt_pk_bf16_f32 v16, v16, v17
    v_cvt_pk_bf16_f32 v17, v18, v19
    v_pk_mul_f32 v[20:21], v[20:21], v[174:175] op_sel_hi:[1,0]
    v_pk_mul_f32 v[22:23], v[22:23], v[174:175] op_sel_hi:[1,0]
    v_exp_f32 v248, v20 clamp
    v_mfma_f32_32x32x16_bf16 v[80:95], v[132:135], a[64:67], v[80:95]
    s_lshl_b32 s62, s72, 4
    s_add_u32 m0, s3, 4096
    ds_read_b64_tr_b16 v[144:145], v213 offset:20480
    ds_read_b64_tr_b16 v[146:147], v213 offset:20736
    buffer_load_dwordx4 v254, s[16:19], s62 offen lds
    v_mfma_f32_16x16x32_bf16 v[192:195], v[204:207], v[132:135], v[192:195]
    v_exp_f32 v249, v21 clamp
    v_exp_f32 v250, v22 clamp
    v_exp_f32 v251, v23 clamp
    v_max_f32 v20, 0, v20
    v_max_f32 v21, 0, v21
    s_waitcnt lgkmcnt(4)
    v_mfma_f32_32x32x16_bf16 v[80:95], v[136:139], a[80:83], v[80:95]
    s_add_u32 m0, s3, 5120
    ds_read_b64_tr_b16 v[148:149], v213 offset:24576
    ds_read_b64_tr_b16 v[150:151], v213 offset:24832
    buffer_load_dwordx4 v255, s[16:19], s62 offen lds
    v_mfma_f32_16x16x32_bf16 v[192:195], v[204:207], v[136:139], v[192:195]
    v_max_f32 v22, 0, v22
    v_max_f32 v23, 0, v23
    v_pk_add_f32 v[248:249], v[248:249], s[66:67] op_sel_hi:[1,0]
    v_pk_add_f32 v[250:251], v[250:251], s[66:67] op_sel_hi:[1,0]
    v_pk_fma_f32 v[20:21], v[20:21], s[68:69], v[248:249] op_sel_hi:[1,0,1]
    s_waitcnt lgkmcnt(2)
    v_mfma_f32_32x32x16_bf16 v[80:95], v[140:143], a[52:55], v[80:95]
    ds_read_b64_tr_b16 v[128:129], v214 offset:16384
    ds_read_b64_tr_b16 v[130:131], v214 offset:16640
    v_pk_fma_f32 v[22:23], v[22:23], s[68:69], v[250:251] op_sel_hi:[1,0,1]
    v_cvt_pk_bf16_f32 v18, v20, v21
    v_cvt_pk_bf16_f32 v19, v22, v23
    buffer_store_dwordx4 v[16:19], v5, s[28:31], s47 offen offset:0 sc1
    v_pk_mul_f32 v[24:25], v[24:25], v[174:175] op_sel_hi:[1,0]
    v_mfma_f32_32x32x16_bf16 v[80:95], v[144:147], a[68:71], v[80:95]
    ds_read_b64_tr_b16 v[132:133], v214 offset:20480
    ds_read_b64_tr_b16 v[134:135], v214 offset:20736
    v_pk_mul_f32 v[26:27], v[26:27], v[174:175] op_sel_hi:[1,0]
    v_exp_f32 v248, v24 clamp
    v_exp_f32 v249, v25 clamp
    v_exp_f32 v250, v26 clamp
    v_exp_f32 v251, v27 clamp
    s_waitcnt lgkmcnt(4)
    v_mfma_f32_32x32x16_bf16 v[80:95], v[148:151], a[84:87], v[80:95]
    ds_read_b64_tr_b16 v[136:137], v214 offset:24576
    ds_read_b64_tr_b16 v[138:139], v214 offset:24832
    v_max_f32 v24, 0, v24
    v_max_f32 v25, 0, v25
    v_max_f32 v26, 0, v26
    v_max_f32 v27, 0, v27
    v_pk_add_f32 v[248:249], v[248:249], s[66:67] op_sel_hi:[1,0]
    s_waitcnt lgkmcnt(2)
    v_mfma_f32_32x32x16_bf16 v[80:95], v[128:131], a[56:59], v[80:95]
    s_waitcnt vmcnt(11)
    s_barrier
    s_add_u32 s39, s39, 0x20000000
    s_mul_hi_u32 s42, s39, 1835008
    s_add_u32 m0, s43, 0
    ds_read_b64_tr_b16 v[140:141], v215 offset:16384
    ds_read_b64_tr_b16 v[142:143], v215 offset:16640
    buffer_load_dwordx4 v225, s[12:15], s42 offen lds
    v_pk_add_f32 v[250:251], v[250:251], s[66:67] op_sel_hi:[1,0]
    v_pk_fma_f32 v[24:25], v[24:25], s[68:69], v[248:249] op_sel_hi:[1,0,1]
    v_pk_fma_f32 v[26:27], v[26:27], s[68:69], v[250:251] op_sel_hi:[1,0,1]
    v_cvt_pk_bf16_f32 v20, v24, v25
    v_cvt_pk_bf16_f32 v21, v26, v27
    v_pk_mul_f32 v[28:29], v[28:29], v[174:175] op_sel_hi:[1,0]
    v_mfma_f32_32x32x16_bf16 v[80:95], v[132:135], a[72:75], v[80:95]
    s_add_u32 m0, s43, 4096
    ds_read_b64_tr_b16 v[144:145], v215 offset:20480
    ds_read_b64_tr_b16 v[146:147], v215 offset:20736
    buffer_load_dwordx4 v226, s[12:15], s42 offen lds
    v_pk_mul_f32 v[30:31], v[30:31], v[174:175] op_sel_hi:[1,0]
    v_exp_f32 v248, v28 clamp
    v_exp_f32 v249, v29 clamp
    v_exp_f32 v250, v30 clamp
    v_exp_f32 v251, v31 clamp
    s_waitcnt lgkmcnt(4)
    v_mfma_f32_32x32x16_bf16 v[80:95], v[136:139], a[88:91], v[80:95]
    s_add_u32 s39, s39, 0x20000000
    s_mul_hi_u32 s42, s39, 1835008
    s_add_u32 m0, s43, 8192
    ds_read_b64_tr_b16 v[148:149], v215 offset:24576
    ds_read_b64_tr_b16 v[150:151], v215 offset:24832
    buffer_load_dwordx4 v225, s[12:15], s42 offen lds
    v_max_f32 v28, 0, v28
    v_max_f32 v29, 0, v29
    v_max_f32 v30, 0, v30
    v_max_f32 v31, 0, v31
    v_pk_add_f32 v[248:249], v[248:249], s[66:67] op_sel_hi:[1,0]
    s_waitcnt lgkmcnt(2)
    v_mfma_f32_32x32x16_bf16 v[80:95], v[140:143], a[60:63], v[80:95]
    s_lshl_b32 s62, s73, 4
    s_add_u32 m0, s3, 6144
    ds_read_b64_tr_b16 v[128:129], v212 offset:32768
    ds_read_b64_tr_b16 v[130:131], v212 offset:33024
    buffer_load_dwordx4 v254, s[16:19], s62 offen lds
    v_pk_add_f32 v[250:251], v[250:251], s[66:67] op_sel_hi:[1,0]
    v_pk_fma_f32 v[28:29], v[28:29], s[68:69], v[248:249] op_sel_hi:[1,0,1]
    v_pk_fma_f32 v[30:31], v[30:31], s[68:69], v[250:251] op_sel_hi:[1,0,1]
    v_cvt_pk_bf16_f32 v22, v28, v29
    v_cvt_pk_bf16_f32 v23, v30, v31
    v_mfma_f32_32x32x16_bf16 v[80:95], v[144:147], a[76:79], v[80:95]
    s_add_u32 m0, s3, 7168
    ds_read_b64_tr_b16 v[132:133], v212 offset:36864
    ds_read_b64_tr_b16 v[134:135], v212 offset:37120
    buffer_load_dwordx4 v255, s[16:19], s62 offen lds
    buffer_store_dwordx4 v[20:23], v5, s[28:31], s47 offen offset:1024 sc1
    v_pk_mul_f32 v[32:33], v[32:33], v[174:175] op_sel_hi:[1,0]
    v_pk_mul_f32 v[34:35], v[34:35], v[174:175] op_sel_hi:[1,0]
    v_exp_f32 v248, v32 clamp
    v_exp_f32 v249, v33 clamp
    s_waitcnt lgkmcnt(4)
    v_mfma_f32_32x32x16_bf16 v[80:95], v[148:151], a[92:95], v[80:95]
    s_lshl_b32 s62, s74, 4
    s_add_u32 m0, s3, 8192
    ds_read_b64_tr_b16 v[136:137], v212 offset:40960
    ds_read_b64_tr_b16 v[138:139], v212 offset:41216
    buffer_load_dwordx4 v254, s[16:19], s62 offen lds
    v_exp_f32 v250, v34 clamp
    v_exp_f32 v251, v35 clamp
    v_max_f32 v32, 0, v32
    v_max_f32 v33, 0, v33
    v_max_f32 v34, 0, v34
    s_waitcnt lgkmcnt(2)
    v_mfma_f32_32x32x16_bf16 v[80:95], v[128:131], a[96:99], v[80:95]
    s_add_u32 m0, s3, 9216
    ds_read_b64_tr_b16 v[140:141], v213 offset:32768
    ds_read_b64_tr_b16 v[142:143], v213 offset:33024
    buffer_load_dwordx4 v255, s[16:19], s62 offen lds
    v_mfma_f32_16x16x32_bf16 v[192:195], v[204:207], v[128:131], v[192:195]
    v_max_f32 v35, 0, v35
    v_pk_add_f32 v[248:249], v[248:249], s[66:67] op_sel_hi:[1,0]
    v_pk_add_f32 v[250:251], v[250:251], s[66:67] op_sel_hi:[1,0]
    v_pk_fma_f32 v[32:33], v[32:33], s[68:69], v[248:249] op_sel_hi:[1,0,1]
    v_pk_fma_f32 v[34:35], v[34:35], s[68:69], v[250:251] op_sel_hi:[1,0,1]
    v_cvt_pk_bf16_f32 v32, v32, v33
    s_waitcnt vmcnt(9)
    ds_read_b64_tr_b16 a[128:129], v12 offset:0
    ds_read_b64_tr_b16 a[130:131], v12 offset:512
    v_mfma_f32_32x32x16_bf16 v[80:95], v[132:135], a[112:115], v[80:95]
    s_lshl_b32 s62, s75, 4
    s_add_u32 m0, s3, 10240
    ds_read_b64_tr_b16 v[144:145], v213 offset:36864
    ds_read_b64_tr_b16 v[146:147], v213 offset:37120
    buffer_load_dwordx4 v254, s[16:19], s62 offen lds
    v_mfma_f32_16x16x32_bf16 v[192:195], v[204:207], v[132:135], v[192:195]
    v_cvt_pk_bf16_f32 v33, v34, v35
    v_pk_mul_f32 v[36:37], v[36:37], v[174:175] op_sel_hi:[1,0]
    v_pk_mul_f32 v[38:39], v[38:39], v[174:175] op_sel_hi:[1,0]
    v_exp_f32 v248, v36 clamp
    v_exp_f32 v249, v37 clamp
    ds_read_b64_tr_b16 a[132:133], v12 offset:1024
    ds_read_b64_tr_b16 a[134:135], v12 offset:1536
    s_waitcnt lgkmcnt(8)
    v_mfma_f32_32x32x16_bf16 v[96:111], v[136:139], a[0:3], 0
    s_add_u32 m0, s3, 11264
    ds_read_b64_tr_b16 v[148:149], v213 offset:40960
    ds_read_b64_tr_b16 v[150:151], v213 offset:41216
    buffer_load_dwordx4 v255, s[16:19], s62 offen lds
    v_mfma_f32_16x16x32_bf16 v[196:199], v[204:207], v[136:139], 0
    v_exp_f32 v250, v38 clamp
    v_exp_f32 v251, v39 clamp
    v_max_f32 v36, 0, v36
    v_max_f32 v37, 0, v37
    v_max_f32 v38, 0, v38
    ds_read_b64_tr_b16 a[136:137], v12 offset:2048
    ds_read_b64_tr_b16 a[138:139], v12 offset:2560
    s_waitcnt lgkmcnt(6)
    v_mfma_f32_32x32x16_bf16 v[80:95], v[140:143], a[100:103], v[80:95]
    ds_read_b64_tr_b16 v[128:129], v214 offset:32768
    ds_read_b64_tr_b16 v[130:131], v214 offset:33024
    v_max_f32 v39, 0, v39
    v_pk_add_f32 v[248:249], v[248:249], s[66:67] op_sel_hi:[1,0]
    v_pk_add_f32 v[250:251], v[250:251], s[66:67] op_sel_hi:[1,0]
    v_pk_fma_f32 v[36:37], v[36:37], s[68:69], v[248:249] op_sel_hi:[1,0,1]
    v_pk_fma_f32 v[38:39], v[38:39], s[68:69], v[250:251] op_sel_hi:[1,0,1]
    v_cvt_pk_bf16_f32 v193, v192, v192
    v_and_b32 v193, s69, v193
    ds_read_b64_tr_b16 a[140:141], v12 offset:3072
    ds_read_b64_tr_b16 a[142:143], v12 offset:3584
    v_mfma_f32_32x32x16_bf16 v[80:95], v[144:147], a[116:119], v[80:95]
    ds_read_b64_tr_b16 v[132:133], v214 offset:36864
    ds_read_b64_tr_b16 v[134:135], v214 offset:37120
    v_cvt_pk_bf16_f32 v34, v36, v37
    v_cvt_pk_bf16_f32 v35, v38, v39
    buffer_store_dwordx4 v[32:35], v5, s[28:31], s48 offen offset:0 sc1
    v_pk_mul_f32 v[40:41], v[40:41], v[174:175] op_sel_hi:[1,0]
    v_pk_mul_f32 v[42:43], v[42:43], v[174:175] op_sel_hi:[1,0]
    v_sub_f32 v193, v192, v193
    v_cvt_pk_bf16_f32 v192, v192, v193
    ds_read_b64_tr_b16 a[144:145], v12 offset:4096
    ds_read_b64_tr_b16 a[146:147], v12 offset:4608
    s_waitcnt lgkmcnt(10)
    v_mfma_f32_32x32x16_bf16 v[96:111], v[148:151], a[4:7], v[96:111]
    ds_read_b64_tr_b16 v[136:137], v214 offset:40960
    ds_read_b64_tr_b16 v[138:139], v214 offset:41216
    v_exp_f32 v248, v40 clamp
    v_exp_f32 v249, v41 clamp
    v_exp_f32 v250, v42 clamp
    v_exp_f32 v251, v43 clamp
    v_max_f32 v40, 0, v40
    ds_write_b32 v3, v192 offset:2048
    ds_read_b64_tr_b16 a[148:149], v12 offset:5120
    ds_read_b64_tr_b16 a[150:151], v12 offset:5632
    s_waitcnt lgkmcnt(7)
    v_mfma_f32_32x32x16_bf16 v[80:95], v[128:131], a[104:107], v[80:95]
    s_waitcnt lgkmcnt(2)
    s_barrier
    s_add_u32 m0, s43, 16384
    ds_read_b64_tr_b16 v[140:141], v215 offset:32768
    ds_read_b64_tr_b16 v[142:143], v215 offset:33024
    buffer_load_dwordx4 v226, s[12:15], s42 offen lds
    v_max_f32 v41, 0, v41
    v_max_f32 v42, 0, v42
    v_max_f32 v43, 0, v43
    v_pk_add_f32 v[248:249], v[248:249], s[66:67] op_sel_hi:[1,0]
    v_pk_add_f32 v[250:251], v[250:251], s[66:67] op_sel_hi:[1,0]
    v_pk_fma_f32 v[40:41], v[40:41], s[68:69], v[248:249] op_sel_hi:[1,0,1]
    v_mfma_f32_32x32x16_bf16 v[80:95], v[132:135], a[120:123], v[80:95]
    s_add_u32 s39, s39, 0x20000000
    s_mul_hi_u32 s42, s39, 1835008
    s_add_u32 m0, s43, 20480
    ds_read_b64_tr_b16 v[144:145], v215 offset:36864
    ds_read_b64_tr_b16 v[146:147], v215 offset:37120
    buffer_load_dwordx4 v225, s[12:15], s42 offen lds
    v_pk_fma_f32 v[42:43], v[42:43], s[68:69], v[250:251] op_sel_hi:[1,0,1]
    v_cvt_pk_bf16_f32 v36, v40, v41
    v_cvt_pk_bf16_f32 v37, v42, v43
    v_pk_mul_f32 v[44:45], v[44:45], v[174:175] op_sel_hi:[1,0]
    v_pk_mul_f32 v[46:47], v[46:47], v[174:175] op_sel_hi:[1,0]
    v_mfma_f32_32x32x16_bf16 v[96:111], v[136:139], a[8:11], v[96:111]
    s_add_u32 m0, s43, 24576
    ds_read_b64_tr_b16 v[148:149], v215 offset:40960
    ds_read_b64_tr_b16 v[150:151], v215 offset:41216
    buffer_load_dwordx4 v226, s[12:15], s42 offen lds
    v_exp_f32 v248, v44 clamp
    v_exp_f32 v249, v45 clamp
    v_exp_f32 v250, v46 clamp
    v_exp_f32 v251, v47 clamp
    v_max_f32 v44, 0, v44
    s_waitcnt lgkmcnt(2)
    v_mfma_f32_32x32x16_bf16 v[80:95], v[140:143], a[108:111], v[80:95]
    s_lshl_b32 s62, s36, 17
    s_add_u32 m0, s3, 0
    ds_read_b64_tr_b16 v[128:129], v212 offset:49152
    ds_read_b64_tr_b16 v[130:131], v212 offset:49408
    buffer_load_dwordx4 v254, s[20:23], s62 offen lds
    v_max_f32 v45, 0, v45
    v_max_f32 v46, 0, v46
    v_max_f32 v47, 0, v47
    v_pk_add_f32 v[248:249], v[248:249], s[66:67] op_sel_hi:[1,0]
    v_pk_add_f32 v[250:251], v[250:251], s[66:67] op_sel_hi:[1,0]
    v_mfma_f32_32x32x16_bf16 v[80:95], v[144:147], a[124:127], v[80:95]
    s_add_u32 m0, s3, 1024
    ds_read_b64_tr_b16 v[132:133], v212 offset:53248
    ds_read_b64_tr_b16 v[134:135], v212 offset:53504
    buffer_load_dwordx4 v255, s[20:23], s62 offen lds
    v_pk_fma_f32 v[44:45], v[44:45], s[68:69], v[248:249] op_sel_hi:[1,0,1]
    v_pk_fma_f32 v[46:47], v[46:47], s[68:69], v[250:251] op_sel_hi:[1,0,1]
    v_cvt_pk_bf16_f32 v38, v44, v45
    v_cvt_pk_bf16_f32 v39, v46, v47
    buffer_store_dwordx4 v[36:39], v5, s[28:31], s48 offen offset:1024 sc1
    s_waitcnt lgkmcnt(4)
    v_mfma_f32_32x32x16_bf16 v[96:111], v[148:151], a[12:15], v[96:111]
    s_lshl_b32 s62, s76, 4
    s_add_u32 m0, s3, 2048
    ds_read_b64_tr_b16 v[136:137], v212 offset:57344
    ds_read_b64_tr_b16 v[138:139], v212 offset:57600
    buffer_load_dwordx4 v254, s[16:19], s62 offen lds
    v_cvt_pk_bf16_f32 v48, v48, v49
    v_cvt_pk_bf16_f32 v49, v50, v51
    v_cvt_pk_bf16_f32 v50, v52, v53
    v_cvt_pk_bf16_f32 v51, v54, v55
    v_pk_max_i16 v48, v48, 0
    s_waitcnt lgkmcnt(2)
    v_mfma_f32_32x32x16_bf16 v[112:127], v[128:131], a[0:3], 0
    s_add_u32 m0, s3, 3072
    ds_read_b64_tr_b16 v[140:141], v213 offset:49152
    ds_read_b64_tr_b16 v[142:143], v213 offset:49408
    buffer_load_dwordx4 v255, s[16:19], s62 offen lds
    v_mfma_f32_16x16x32_bf16 v[200:203], v[204:207], v[128:131], 0
    v_pk_max_i16 v49, v49, 0
    v_pk_max_i16 v50, v50, 0
    v_pk_max_i16 v51, v51, 0
    buffer_store_dwordx4 v[48:51], v4, s[28:31], s49 offen offset:0 sc1
    v_cvt_pk_bf16_f32 v52, v56, v57
    v_cvt_pk_bf16_f32 v53, v58, v59
    s_waitcnt vmcnt(10)
    ds_read_b64_tr_b16 a[152:153], v12 offset:6144
    ds_read_b64_tr_b16 a[154:155], v12 offset:6656
    v_mfma_f32_32x32x16_bf16 v[96:111], v[132:135], a[16:19], v[96:111]
    s_lshl_b32 s62, s36, 17
    s_add_u32 s62, s62, 16384
    s_add_u32 m0, s3, 4096
    ds_read_b64_tr_b16 v[144:145], v213 offset:53248
    ds_read_b64_tr_b16 v[146:147], v213 offset:53504
    buffer_load_dwordx4 v254, s[20:23], s62 offen lds
    v_mfma_f32_16x16x32_bf16 v[196:199], v[204:207], v[132:135], v[196:199]
    v_cvt_pk_bf16_f32 v54, v60, v61
    v_cvt_pk_bf16_f32 v55, v62, v63
    v_pk_max_i16 v52, v52, 0
    v_pk_max_i16 v53, v53, 0
    v_pk_max_i16 v54, v54, 0
    ds_read_b64_tr_b16 a[156:157], v12 offset:7168
    ds_read_b64_tr_b16 a[158:159], v12 offset:7680
    s_waitcnt lgkmcnt(8)
    v_mfma_f32_32x32x16_bf16 v[112:127], v[136:139], a[16:19], v[112:127]
    s_add_u32 m0, s3, 5120
    ds_read_b64_tr_b16 v[148:149], v213 offset:57344
    ds_read_b64_tr_b16 v[150:151], v213 offset:57600
    buffer_load_dwordx4 v255, s[20:23], s62 offen lds
    v_mfma_f32_16x16x32_bf16 v[200:203], v[204:207], v[136:139], v[200:203]
    v_pk_max_i16 v55, v55, 0
    buffer_store_dwordx4 v[52:55], v4, s[28:31], s49 offen offset:1024 sc1
    v_cvt_pk_bf16_f32 v64, v64, v65
    v_cvt_pk_bf16_f32 v65, v66, v67
    v_cvt_pk_bf16_f32 v66, v68, v69
    ds_read_b64_tr_b16 a[160:161], v12 offset:8192
    ds_read_b64_tr_b16 a[162:163], v12 offset:8704
    s_waitcnt lgkmcnt(6)
    v_mfma_f32_32x32x16_bf16 v[112:127], v[140:143], a[4:7], v[112:127]
    ds_read_b64_tr_b16 v[128:129], v214 offset:49152
    ds_read_b64_tr_b16 v[130:131], v214 offset:49408
    v_cvt_pk_bf16_f32 v67, v70, v71
    v_pk_max_i16 v64, v64, 0
    v_pk_max_i16 v65, v65, 0
    v_pk_max_i16 v66, v66, 0
    v_pk_max_i16 v67, v67, 0
    ds_read_b64_tr_b16 a[164:165], v12 offset:9216
    ds_read_b64_tr_b16 a[166:167], v12 offset:9728
    v_mfma_f32_32x32x16_bf16 v[96:111], v[144:147], a[20:23], v[96:111]
    ds_read_b64_tr_b16 v[132:133], v214 offset:53248
    ds_read_b64_tr_b16 v[134:135], v214 offset:53504
    buffer_store_dwordx4 v[64:67], v4, s[28:31], s50 offen offset:0 sc1
    v_cvt_pk_bf16_f32 v68, v72, v73
    v_cvt_pk_bf16_f32 v69, v74, v75
    v_cvt_pk_bf16_f32 v70, v76, v77
    v_cvt_pk_bf16_f32 v71, v78, v79
    ds_read_b64_tr_b16 a[168:169], v12 offset:10240
    ds_read_b64_tr_b16 a[170:171], v12 offset:10752
    s_waitcnt lgkmcnt(10)
    v_mfma_f32_32x32x16_bf16 v[112:127], v[148:151], a[20:23], v[112:127]
    ds_read_b64_tr_b16 v[136:137], v214 offset:57344
    ds_read_b64_tr_b16 v[138:139], v214 offset:57600
    v_pk_max_i16 v68, v68, 0
    v_pk_max_i16 v69, v69, 0
    v_pk_max_i16 v70, v70, 0
    v_pk_max_i16 v71, v71, 0
    buffer_store_dwordx4 v[68:71], v4, s[28:31], s50 offen offset:1024 sc1
    ds_read_b64_tr_b16 a[172:173], v12 offset:11264
    ds_read_b64_tr_b16 a[174:175], v12 offset:11776
    s_waitcnt lgkmcnt(6)
    v_mfma_f32_32x32x16_bf16 v[112:127], v[128:131], a[8:11], v[112:127]
    s_barrier
    s_add_u32 s39, s39, 0x20000000
    s_mul_hi_u32 s42, s39, 1835008
    s_add_u32 m0, s43, 32768
    ds_read_b64_tr_b16 v[140:141], v215 offset:49152
    ds_read_b64_tr_b16 v[142:143], v215 offset:49408
    buffer_load_dwordx4 v225, s[12:15], s42 offen lds
    ds_read_b128 v[192:195], v6 offset:2048
    s_waitcnt lgkmcnt(0)
    v_mfma_f32_32x32x16_bf16 v[80:95], v[192:195], v[8:11], v[80:95]
    v_mfma_f32_32x32x16_bf16 v[96:111], v[132:135], a[24:27], v[96:111]
    s_add_u32 m0, s43, 36864
    ds_read_b64_tr_b16 v[144:145], v215 offset:53248
    ds_read_b64_tr_b16 v[146:147], v215 offset:53504
    buffer_load_dwordx4 v226, s[12:15], s42 offen lds
    s_nop 11
    v_cvt_pk_bf16_f32 v80, v80, v81
    v_mfma_f32_32x32x16_bf16 v[112:127], v[136:139], a[24:27], v[112:127]
    s_add_u32 s39, s39, 0x20000000
    s_mul_hi_u32 s42, s39, 1835008
    s_add_u32 m0, s43, 40960
    ds_read_b64_tr_b16 v[148:149], v215 offset:57344
    ds_read_b64_tr_b16 v[150:151], v215 offset:57600
    buffer_load_dwordx4 v225, s[12:15], s42 offen lds
    v_cvt_pk_bf16_f32 v81, v82, v83
    v_cvt_pk_bf16_f32 v82, v84, v85
    v_cvt_pk_bf16_f32 v83, v86, v87
    s_waitcnt lgkmcnt(2)
    v_mfma_f32_32x32x16_bf16 v[112:127], v[140:143], a[12:15], v[112:127]
    s_lshl_b32 s62, s77, 4
    s_add_u32 m0, s3, 6144
    ds_read_b64_tr_b16 v[128:129], v212 offset:0
    ds_read_b64_tr_b16 v[130:131], v212 offset:256
    buffer_load_dwordx4 v254, s[16:19], s62 offen lds
    v_pk_max_i16 v80, v80, 0
    v_pk_max_i16 v81, v81, 0
    v_mfma_f32_32x32x16_bf16 v[96:111], v[144:147], a[28:31], v[96:111]
    s_add_u32 m0, s3, 7168
    ds_read_b64_tr_b16 v[132:133], v212 offset:4096
    ds_read_b64_tr_b16 v[134:135], v212 offset:4352
    buffer_load_dwordx4 v255, s[16:19], s62 offen lds
    v_pk_max_i16 v82, v82, 0
    v_pk_max_i16 v83, v83, 0
    buffer_store_dwordx4 v[80:83], v4, s[28:31], s51 offen offset:0 sc1
    s_waitcnt lgkmcnt(4)
    v_mfma_f32_32x32x16_bf16 v[112:127], v[148:151], a[28:31], v[112:127]
    s_lshl_b32 s62, s36, 17
    s_add_u32 s62, s62, 32768
    s_add_u32 m0, s3, 8192
    ds_read_b64_tr_b16 v[136:137], v212 offset:8192
    ds_read_b64_tr_b16 v[138:139], v212 offset:8448
    buffer_load_dwordx4 v254, s[20:23], s62 offen lds
    v_cvt_pk_bf16_f32 v84, v88, v89
    v_cvt_pk_bf16_f32 v85, v90, v91
    s_waitcnt lgkmcnt(2)
    v_mfma_f32_32x32x16_bf16 v[96:111], v[128:131], a[32:35], v[96:111]
    s_add_u32 m0, s3, 9216
    ds_read_b64_tr_b16 v[140:141], v213 offset:0
    ds_read_b64_tr_b16 v[142:143], v213 offset:256
    buffer_load_dwordx4 v255, s[20:23], s62 offen lds
    v_mfma_f32_16x16x32_bf16 v[196:199], v[204:207], v[128:131], v[196:199]
    v_cvt_pk_bf16_f32 v86, v92, v93
    v_cvt_pk_bf16_f32 v87, v94, v95
    v_pk_max_i16 v84, v84, 0
    s_waitcnt vmcnt(11)
    ds_read_b64_tr_b16 a[176:177], v12 offset:0
    ds_read_b64_tr_b16 a[178:179], v12 offset:512
    v_mfma_f32_32x32x16_bf16 v[112:127], v[132:135], a[32:35], v[112:127]
    s_lshl_b32 s62, s78, 4
    s_add_u32 m0, s3, 10240
    ds_read_b64_tr_b16 v[144:145], v213 offset:4096
    ds_read_b64_tr_b16 v[146:147], v213 offset:4352
    buffer_load_dwordx4 v254, s[16:19], s62 offen lds
    v_mfma_f32_16x16x32_bf16 v[200:203], v[204:207], v[132:135], v[200:203]
    v_pk_max_i16 v85, v85, 0
    v_pk_max_i16 v86, v86, 0
    ds_read_b64_tr_b16 a[180:181], v12 offset:1024
    ds_read_b64_tr_b16 a[182:183], v12 offset:1536
    s_waitcnt lgkmcnt(8)
    v_mfma_f32_32x32x16_bf16 v[96:111], v[136:139], a[48:51], v[96:111]
    s_add_u32 m0, s3, 11264
    ds_read_b64_tr_b16 v[148:149], v213 offset:8192
    ds_read_b64_tr_b16 v[150:151], v213 offset:8448
    buffer_load_dwordx4 v255, s[16:19], s62 offen lds
    v_mfma_f32_16x16x32_bf16 v[196:199], v[204:207], v[136:139], v[196:199]
    v_pk_max_i16 v87, v87, 0
    buffer_store_dwordx4 v[84:87], v4, s[28:31], s51 offen offset:1024 sc1
    ds_read_b64_tr_b16 a[184:185], v12 offset:2048
    ds_read_b64_tr_b16 a[186:187], v12 offset:2560
    s_waitcnt lgkmcnt(6)
    v_mfma_f32_32x32x16_bf16 v[96:111], v[140:143], a[36:39], v[96:111]
    ds_read_b64_tr_b16 v[128:129], v214 offset:0
    ds_read_b64_tr_b16 v[130:131], v214 offset:256
    ds_read_b64_tr_b16 a[188:189], v12 offset:3072
    ds_read_b64_tr_b16 a[190:191], v12 offset:3584
    v_mfma_f32_32x32x16_bf16 v[112:127], v[144:147], a[36:39], v[112:127]
    ds_read_b64_tr_b16 v[132:133], v214 offset:4096
    ds_read_b64_tr_b16 v[134:135], v214 offset:4352
    ds_read_b64_tr_b16 a[192:193], v12 offset:4096
    ds_read_b64_tr_b16 a[194:195], v12 offset:4608
    s_waitcnt lgkmcnt(10)
    v_mfma_f32_32x32x16_bf16 v[96:111], v[148:151], a[52:55], v[96:111]
    ds_read_b64_tr_b16 v[136:137], v214 offset:8192
    ds_read_b64_tr_b16 v[138:139], v214 offset:8448
    ds_read_b64_tr_b16 a[196:197], v12 offset:5120
    ds_read_b64_tr_b16 a[198:199], v12 offset:5632
    s_waitcnt lgkmcnt(6)
    v_mfma_f32_32x32x16_bf16 v[96:111], v[128:131], a[40:43], v[96:111]
    s_barrier
    s_add_u32 m0, s43, 49152
    ds_read_b64_tr_b16 v[140:141], v215 offset:0
    ds_read_b64_tr_b16 v[142:143], v215 offset:256
    buffer_load_dwordx4 v226, s[12:15], s42 offen lds
    v_mfma_f32_32x32x16_bf16 v[112:127], v[132:135], a[40:43], v[112:127]
    s_add_u32 s39, s39, 0x20000000
    s_mul_hi_u32 s42, s39, 1835008
    s_add_u32 m0, s43, 53248
    ds_read_b64_tr_b16 v[144:145], v215 offset:4096
    ds_read_b64_tr_b16 v[146:147], v215 offset:4352
    buffer_load_dwordx4 v225, s[12:15], s42 offen lds
    s_waitcnt lgkmcnt(6)
    v_mfma_f32_32x32x16_bf16 v[96:111], v[136:139], a[56:59], v[96:111]
    s_add_u32 m0, s43, 57344
    ds_read_b64_tr_b16 v[148:149], v215 offset:8192
    ds_read_b64_tr_b16 v[150:151], v215 offset:8448
    buffer_load_dwordx4 v226, s[12:15], s42 offen lds
    s_waitcnt lgkmcnt(2)
    v_mfma_f32_32x32x16_bf16 v[96:111], v[140:143], a[44:47], v[96:111]
    s_lshl_b32 s62, s36, 17
    s_add_u32 s62, s62, 49152
    s_add_u32 m0, s3, 0
    ds_read_b64_tr_b16 v[128:129], v212 offset:16384
    ds_read_b64_tr_b16 v[130:131], v212 offset:16640
    buffer_load_dwordx4 v254, s[20:23], s62 offen lds
    v_mfma_f32_32x32x16_bf16 v[112:127], v[144:147], a[44:47], v[112:127]
    s_add_u32 m0, s3, 1024
    ds_read_b64_tr_b16 v[132:133], v212 offset:20480
    ds_read_b64_tr_b16 v[134:135], v212 offset:20736
    buffer_load_dwordx4 v255, s[20:23], s62 offen lds
    s_waitcnt lgkmcnt(4)
    v_mfma_f32_32x32x16_bf16 v[96:111], v[148:151], a[60:63], v[96:111]
    s_lshl_b32 s62, s79, 4
    s_add_u32 m0, s3, 2048
    ds_read_b64_tr_b16 v[136:137], v212 offset:24576
    ds_read_b64_tr_b16 v[138:139], v212 offset:24832
    buffer_load_dwordx4 v254, s[16:19], s62 offen lds
    s_waitcnt lgkmcnt(2)
    v_mfma_f32_32x32x16_bf16 v[112:127], v[128:131], a[48:51], v[112:127]
    s_add_u32 m0, s3, 3072
    ds_read_b64_tr_b16 v[140:141], v213 offset:16384
    ds_read_b64_tr_b16 v[142:143], v213 offset:16640
    buffer_load_dwordx4 v255, s[16:19], s62 offen lds
    v_mfma_f32_16x16x32_bf16 v[200:203], v[204:207], v[128:131], v[200:203]
    s_waitcnt vmcnt(8)
    ds_read_b64_tr_b16 a[200:201], v12 offset:6144
    ds_read_b64_tr_b16 a[202:203], v12 offset:6656
    v_mfma_f32_32x32x16_bf16 v[96:111], v[132:135], a[64:67], v[96:111]
    s_lshl_b32 s62, s36, 17
    s_add_u32 s62, s62, 65536
    s_add_u32 m0, s3, 4096
    ds_read_b64_tr_b16 v[144:145], v213 offset:20480
    ds_read_b64_tr_b16 v[146:147], v213 offset:20736
    buffer_load_dwordx4 v254, s[20:23], s62 offen lds
    v_mfma_f32_16x16x32_bf16 v[196:199], v[204:207], v[132:135], v[196:199]
    ds_read_b64_tr_b16 a[204:205], v12 offset:7168
    ds_read_b64_tr_b16 a[206:207], v12 offset:7680
    s_waitcnt lgkmcnt(8)
    v_mfma_f32_32x32x16_bf16 v[112:127], v[136:139], a[64:67], v[112:127]
    s_add_u32 m0, s3, 5120
    ds_read_b64_tr_b16 v[148:149], v213 offset:24576
    ds_read_b64_tr_b16 v[150:151], v213 offset:24832
    buffer_load_dwordx4 v255, s[20:23], s62 offen lds
    v_mfma_f32_16x16x32_bf16 v[200:203], v[204:207], v[136:139], v[200:203]
    ds_read_b64_tr_b16 a[208:209], v12 offset:8192
    ds_read_b64_tr_b16 a[210:211], v12 offset:8704
    s_waitcnt lgkmcnt(6)
    v_mfma_f32_32x32x16_bf16 v[112:127], v[140:143], a[52:55], v[112:127]
    ds_read_b64_tr_b16 v[128:129], v214 offset:16384
    ds_read_b64_tr_b16 v[130:131], v214 offset:16640
    s_waitcnt vmcnt(9)
    v_mov_b32 v244, s44
    v_mov_b32 v245, s45
    v_mov_b32 v246, 14680064
    s_mov_b64 exec, 1
    buffer_store_dwordx2 v[244:245], v246, s[28:31], s40 offen sc1
    s_mov_b64 exec, -1
    ds_read_b64_tr_b16 a[212:213], v12 offset:9216
    ds_read_b64_tr_b16 a[214:215], v12 offset:9728
    v_mfma_f32_32x32x16_bf16 v[96:111], v[144:147], a[68:71], v[96:111]
    ds_read_b64_tr_b16 v[132:133], v214 offset:20480
    ds_read_b64_tr_b16 v[134:135], v214 offset:20736
    ds_read_b64_tr_b16 a[216:217], v12 offset:10240
    ds_read_b64_tr_b16 a[218:219], v12 offset:10752
    s_waitcnt lgkmcnt(10)
    v_mfma_f32_32x32x16_bf16 v[112:127], v[148:151], a[68:71], v[112:127]
    ds_read_b64_tr_b16 v[136:137], v214 offset:24576
    ds_read_b64_tr_b16 v[138:139], v214 offset:24832
    ds_read_b64_tr_b16 a[220:221], v12 offset:11264
    ds_read_b64_tr_b16 a[222:223], v12 offset:11776
    s_waitcnt lgkmcnt(6)
    v_mfma_f32_32x32x16_bf16 v[112:127], v[128:131], a[56:59], v[112:127]
    s_barrier
    s_lshl_b32 s62, s80, 4
    s_add_u32 m0, s3, 6144
    ds_read_b64_tr_b16 v[140:141], v215 offset:16384
    ds_read_b64_tr_b16 v[142:143], v215 offset:16640
    buffer_load_dwordx4 v254, s[16:19], s62 offen lds
    v_mfma_f32_32x32x16_bf16 v[96:111], v[132:135], a[72:75], v[96:111]
    s_add_u32 m0, s3, 7168
    ds_read_b64_tr_b16 v[144:145], v215 offset:20480
    ds_read_b64_tr_b16 v[146:147], v215 offset:20736
    buffer_load_dwordx4 v255, s[16:19], s62 offen lds
    s_waitcnt lgkmcnt(6)
    v_mfma_f32_32x32x16_bf16 v[112:127], v[136:139], a[72:75], v[112:127]
    s_lshl_b32 s62, s36, 17
    s_add_u32 s62, s62, 81920
    s_add_u32 m0, s3, 8192
    ds_read_b64_tr_b16 v[148:149], v215 offset:24576
    ds_read_b64_tr_b16 v[150:151], v215 offset:24832
    buffer_load_dwordx4 v254, s[20:23], s62 offen lds
    s_waitcnt lgkmcnt(2)
    v_mfma_f32_32x32x16_bf16 v[112:127], v[140:143], a[60:63], v[112:127]
    s_add_u32 m0, s3, 9216
    ds_read_b64_tr_b16 v[128:129], v212 offset:32768
    ds_read_b64_tr_b16 v[130:131], v212 offset:33024
    buffer_load_dwordx4 v255, s[20:23], s62 offen lds
    v_mfma_f32_32x32x16_bf16 v[96:111], v[144:147], a[76:79], v[96:111]
    s_lshl_b32 s62, s81, 4
    s_add_u32 m0, s3, 10240
    ds_read_b64_tr_b16 v[132:133], v212 offset:36864
    ds_read_b64_tr_b16 v[134:135], v212 offset:37120
    buffer_load_dwordx4 v254, s[16:19], s62 offen lds
    s_waitcnt lgkmcnt(4)
    v_mfma_f32_32x32x16_bf16 v[112:127], v[148:151], a[76:79], v[112:127]
    s_add_u32 m0, s3, 11264
    ds_read_b64_tr_b16 v[136:137], v212 offset:40960
    ds_read_b64_tr_b16 v[138:139], v212 offset:41216
    buffer_load_dwordx4 v255, s[16:19], s62 offen lds
    s_waitcnt lgkmcnt(2)
    v_mfma_f32_32x32x16_bf16 v[96:111], v[128:131], a[80:83], v[96:111]
    ds_read_b64_tr_b16 v[140:141], v213 offset:32768
    ds_read_b64_tr_b16 v[142:143], v213 offset:33024
    v_mfma_f32_16x16x32_bf16 v[196:199], v[204:207], v[128:131], v[196:199]
    s_waitcnt vmcnt(7)
    ds_read_b64_tr_b16 a[224:225], v12 offset:0
    ds_read_b64_tr_b16 a[226:227], v12 offset:512
    v_mfma_f32_32x32x16_bf16 v[112:127], v[132:135], a[80:83], v[112:127]
    ds_read_b64_tr_b16 v[144:145], v213 offset:36864
    ds_read_b64_tr_b16 v[146:147], v213 offset:37120
    v_mfma_f32_16x16x32_bf16 v[200:203], v[204:207], v[132:135], v[200:203]
    ds_read_b64_tr_b16 a[228:229], v12 offset:1024
    ds_read_b64_tr_b16 a[230:231], v12 offset:1536
    s_waitcnt lgkmcnt(8)
    v_mfma_f32_32x32x16_bf16 v[96:111], v[136:139], a[96:99], v[96:111]
    ds_read_b64_tr_b16 v[148:149], v213 offset:40960
    ds_read_b64_tr_b16 v[150:151], v213 offset:41216
    v_mfma_f32_16x16x32_bf16 v[196:199], v[204:207], v[136:139], v[196:199]
    ds_read_b64_tr_b16 a[232:233], v12 offset:2048
    ds_read_b64_tr_b16 a[234:235], v12 offset:2560
    s_waitcnt lgkmcnt(6)
    v_mfma_f32_32x32x16_bf16 v[96:111], v[140:143], a[84:87], v[96:111]
    ds_read_b64_tr_b16 v[128:129], v214 offset:32768
    ds_read_b64_tr_b16 v[130:131], v214 offset:33024
    ds_read_b64_tr_b16 a[236:237], v12 offset:3072
    ds_read_b64_tr_b16 a[238:239], v12 offset:3584
    v_mfma_f32_32x32x16_bf16 v[112:127], v[144:147], a[84:87], v[112:127]
    ds_read_b64_tr_b16 v[132:133], v214 offset:36864
    ds_read_b64_tr_b16 v[134:135], v214 offset:37120
    ds_read_b64_tr_b16 a[240:241], v12 offset:4096
    ds_read_b64_tr_b16 a[242:243], v12 offset:4608
    s_waitcnt lgkmcnt(10)
    v_mfma_f32_32x32x16_bf16 v[96:111], v[148:151], a[100:103], v[96:111]
    ds_read_b64_tr_b16 v[136:137], v214 offset:40960
    ds_read_b64_tr_b16 v[138:139], v214 offset:41216
    ds_read_b64_tr_b16 a[244:245], v12 offset:5120
    ds_read_b64_tr_b16 a[246:247], v12 offset:5632
    s_waitcnt lgkmcnt(6)
    v_mfma_f32_32x32x16_bf16 v[96:111], v[128:131], a[88:91], v[96:111]
    s_barrier
    buffer_load_dwordx2 v[176:177], v241, s[28:31], 0 offen sc1
    buffer_load_dwordx2 v[228:229], v233, s[28:31], 0 offen sc1
    s_lshl_b32 s62, s36, 17
    s_add_u32 s62, s62, 98304
    s_add_u32 m0, s3, 0
    ds_read_b64_tr_b16 v[140:141], v215 offset:32768
    ds_read_b64_tr_b16 v[142:143], v215 offset:33024
    buffer_load_dwordx4 v254, s[20:23], s62 offen lds
    v_mfma_f32_32x32x16_bf16 v[112:127], v[132:135], a[88:91], v[112:127]
    s_add_u32 m0, s3, 1024
    ds_read_b64_tr_b16 v[144:145], v215 offset:36864
    ds_read_b64_tr_b16 v[146:147], v215 offset:37120
    buffer_load_dwordx4 v255, s[20:23], s62 offen lds
    s_waitcnt lgkmcnt(6)
    v_mfma_f32_32x32x16_bf16 v[96:111], v[136:139], a[104:107], v[96:111]
    s_lshl_b32 s62, s82, 4
    s_add_u32 m0, s3, 2048
    ds_read_b64_tr_b16 v[148:149], v215 offset:40960
    ds_read_b64_tr_b16 v[150:151], v215 offset:41216
    buffer_load_dwordx4 v254, s[16:19], s62 offen lds
    s_waitcnt lgkmcnt(2)
    v_mfma_f32_32x32x16_bf16 v[96:111], v[140:143], a[92:95], v[96:111]
    s_add_u32 m0, s3, 3072
    ds_read_b64_tr_b16 v[128:129], v212 offset:49152
    ds_read_b64_tr_b16 v[130:131], v212 offset:49408
    buffer_load_dwordx4 v255, s[16:19], s62 offen lds
    v_mfma_f32_32x32x16_bf16 v[112:127], v[144:147], a[92:95], v[112:127]
    s_lshl_b32 s62, s36, 17
    s_add_u32 s62, s62, 114688
    s_add_u32 m0, s3, 4096
    ds_read_b64_tr_b16 v[132:133], v212 offset:53248
    ds_read_b64_tr_b16 v[134:135], v212 offset:53504
    buffer_load_dwordx4 v254, s[20:23], s62 offen lds
    s_waitcnt lgkmcnt(4)
    v_mfma_f32_32x32x16_bf16 v[96:111], v[148:151], a[108:111], v[96:111]
    s_add_u32 m0, s3, 5120
    ds_read_b64_tr_b16 v[136:137], v212 offset:57344
    ds_read_b64_tr_b16 v[138:139], v212 offset:57600
    buffer_load_dwordx4 v255, s[20:23], s62 offen lds
    s_waitcnt lgkmcnt(2)
    v_mfma_f32_32x32x16_bf16 v[112:127], v[128:131], a[96:99], v[112:127]
    ds_read_b64_tr_b16 v[140:141], v213 offset:49152
    ds_read_b64_tr_b16 v[142:143], v213 offset:49408
    v_mfma_f32_16x16x32_bf16 v[200:203], v[204:207], v[128:131], v[200:203]
    v_mfma_f32_32x32x16_bf16 v[96:111], v[132:135], a[112:115], v[96:111]
    ds_read_b64_tr_b16 v[144:145], v213 offset:53248
    ds_read_b64_tr_b16 v[146:147], v213 offset:53504
    v_mfma_f32_16x16x32_bf16 v[196:199], v[204:207], v[132:135], v[196:199]
    s_waitcnt lgkmcnt(4)
    v_mfma_f32_32x32x16_bf16 v[112:127], v[136:139], a[112:115], v[112:127]
    ds_read_b64_tr_b16 v[148:149], v213 offset:57344
    ds_read_b64_tr_b16 v[150:151], v213 offset:57600
    v_mfma_f32_16x16x32_bf16 v[200:203], v[204:207], v[136:139], v[200:203]
    s_waitcnt lgkmcnt(2)
    v_mfma_f32_32x32x16_bf16 v[112:127], v[140:143], a[100:103], v[112:127]
    ds_read_b64_tr_b16 v[128:129], v214 offset:49152
    ds_read_b64_tr_b16 v[130:131], v214 offset:49408
    s_nop 3
    v_cvt_pk_bf16_f32 v197, v196, v196
    v_cvt_pk_bf16_f32 v201, v200, v200
    v_and_b32 v197, s69, v197
    v_mfma_f32_32x32x16_bf16 v[96:111], v[144:147], a[116:119], v[96:111]
    ds_read_b64_tr_b16 v[132:133], v214 offset:53248
    ds_read_b64_tr_b16 v[134:135], v214 offset:53504
    v_and_b32 v201, s69, v201
    v_sub_f32 v197, v196, v197
    v_sub_f32 v201, v200, v201
    v_cvt_pk_bf16_f32 v196, v196, v197
    s_waitcnt lgkmcnt(4)
    v_mfma_f32_32x32x16_bf16 v[112:127], v[148:151], a[116:119], v[112:127]
    ds_read_b64_tr_b16 v[136:137], v214 offset:57344
    ds_read_b64_tr_b16 v[138:139], v214 offset:57600
    v_cvt_pk_bf16_f32 v200, v200, v201
    ds_write_b32 v3, v196 offset:2560
    ds_write_b32 v3, v200 offset:3072
    s_waitcnt lgkmcnt(4)
    v_mfma_f32_32x32x16_bf16 v[112:127], v[128:131], a[104:107], v[112:127]
    s_waitcnt lgkmcnt(0)
    s_barrier
    ds_read_b64_tr_b16 v[140:141], v215 offset:49152
    ds_read_b64_tr_b16 v[142:143], v215 offset:49408
    ds_read_b128 v[196:199], v6 offset:2560
    ds_read_b128 v[200:203], v6 offset:3072
    v_mfma_f32_32x32x16_bf16 v[96:111], v[132:135], a[120:123], v[96:111]
    ds_read_b64_tr_b16 v[144:145], v215 offset:53248
    ds_read_b64_tr_b16 v[146:147], v215 offset:53504
    s_waitcnt vmcnt(6)
    v_cmp_ne_u64 vcc, s[44:45], v[228:229]
    s_cmp_eq_u64 vcc, 0
    s_cselect_b32 s42, 0, 0x20000000
    v_add_u32 v234, s42, v234
    v_add_u32 v235, s42, v235
    v_mfma_f32_32x32x16_bf16 v[112:127], v[136:139], a[120:123], v[112:127]
    ds_read_b64_tr_b16 v[148:149], v215 offset:57344
    ds_read_b64_tr_b16 v[150:151], v215 offset:57600
    s_waitcnt lgkmcnt(2)
    v_mfma_f32_32x32x16_bf16 v[112:127], v[140:143], a[108:111], v[112:127]
    v_mfma_f32_32x32x16_bf16 v[96:111], v[144:147], a[124:127], v[96:111]
    s_waitcnt lgkmcnt(0)
    v_mfma_f32_32x32x16_bf16 v[112:127], v[148:151], a[124:127], v[112:127]
    s_barrier
    v_mfma_f32_32x32x16_bf16 v[96:111], v[196:199], v[8:11], v[96:111]
    v_mfma_f32_32x32x16_bf16 v[112:127], v[200:203], v[8:11], v[112:127]
    s_waitcnt lgkmcnt(0)
    s_mul_i32 s43, s36, 24576
    v_subrev_u32 v238, s3, v12
    v_add_u32 v238, s43, v238
    s_nop 7
    v_cvt_pk_bf16_f32 v96, v96, v97
    v_cvt_pk_bf16_f32 v97, v98, v99
    v_cvt_pk_bf16_f32 v98, v100, v101
    v_cvt_pk_bf16_f32 v99, v102, v103
    v_pk_max_i16 v96, v96, 0
    v_pk_max_i16 v97, v97, 0
    v_pk_max_i16 v98, v98, 0
    v_pk_max_i16 v99, v99, 0
    buffer_store_dwordx4 v[96:99], v4, s[28:31], s52 offen offset:0 sc1
    v_cvt_pk_bf16_f32 v100, v104, v105
    v_cvt_pk_bf16_f32 v101, v106, v107
    v_cvt_pk_bf16_f32 v102, v108, v109
    v_cvt_pk_bf16_f32 v103, v110, v111
    v_pk_max_i16 v100, v100, 0
    v_pk_max_i16 v101, v101, 0
    v_pk_max_i16 v102, v102, 0
    v_pk_max_i16 v103, v103, 0
    buffer_store_dwordx4 v[100:103], v4, s[28:31], s52 offen offset:1024 sc1
    v_cvt_pk_bf16_f32 v112, v112, v113
    v_cvt_pk_bf16_f32 v113, v114, v115
    v_cvt_pk_bf16_f32 v114, v116, v117
    v_cvt_pk_bf16_f32 v115, v118, v119
    v_pk_max_i16 v112, v112, 0
    v_pk_max_i16 v113, v113, 0
    v_pk_max_i16 v114, v114, 0
    v_pk_max_i16 v115, v115, 0
    buffer_store_dwordx4 v[112:115], v4, s[28:31], s53 offen offset:0 sc1
    v_cvt_pk_bf16_f32 v116, v120, v121
    v_cvt_pk_bf16_f32 v117, v122, v123
    v_cvt_pk_bf16_f32 v118, v124, v125
    v_cvt_pk_bf16_f32 v119, v126, v127
    v_pk_max_i16 v116, v116, 0
    v_pk_max_i16 v117, v117, 0
    v_pk_max_i16 v118, v118, 0
    v_pk_max_i16 v119, v119, 0
    buffer_store_dwordx4 v[116:119], v4, s[28:31], s53 offen offset:1024 sc1
    buffer_load_dwordx4 v[16:19], v234, s[28:31], s70 offen
    buffer_load_dwordx4 v[20:23], v235, s[28:31], s70 offen
    buffer_load_dwordx4 v[24:27], v234, s[28:31], s71 offen
    buffer_load_dwordx4 v[28:31], v235, s[28:31], s71 offen
    buffer_load_dwordx4 v[32:35], v234, s[28:31], s72 offen
    buffer_load_dwordx4 v[36:39], v235, s[28:31], s72 offen
    buffer_load_dwordx4 v[40:43], v234, s[28:31], s73 offen
    buffer_load_dwordx4 v[44:47], v235, s[28:31], s73 offen
    buffer_load_dwordx4 v[48:51], v234, s[28:31], s74 offen
    buffer_load_dwordx4 v[52:55], v235, s[28:31], s74 offen
    buffer_load_dwordx4 v[56:59], v234, s[28:31], s75 offen
    buffer_load_dwordx4 v[60:63], v235, s[28:31], s75 offen
    buffer_load_dwordx4 v[64:67], v234, s[28:31], s76 offen
    buffer_load_dwordx4 v[68:71], v235, s[28:31], s76 offen
    buffer_load_dwordx4 v[72:75], v234, s[28:31], s77 offen
    buffer_load_dwordx4 v[76:79], v235, s[28:31], s77 offen
    s_cmp_eq_u32 s42, 0
    s_cbranch_scc1 feok_12
    v_subrev_u32 v234, s42, v234
    v_subrev_u32 v235, s42, v235
    s_waitcnt vmcnt(0)
    v_mov_b32 v244, s44
    v_mov_b32 v245, s45
    v_mov_b32 v246, 14680064
    s_mov_b64 exec, 1
    buffer_store_dwordx2 v[244:245], v246, s[28:31], s41 offen sc1
    s_mov_b64 exec, -1
    s_mov_b32 s67, 0x8000
poll_13:
    buffer_load_dwordx2 v[228:229], v233, s[28:31], 0 offen sc1
    s_waitcnt vmcnt(0)
    v_cmp_ne_u64 vcc, s[44:45], v[228:229]
    s_cbranch_vccz polld_14
    s_sub_u32 s67, s67, 1
    s_cmp_lg_u32 s67, 0
    s_cbranch_scc1 poll_13
polld_14:
    buffer_load_dwordx4 v[16:19], v234, s[28:31], s70 offen
    buffer_load_dwordx4 v[20:23], v235, s[28:31], s70 offen
    buffer_load_dwordx4 v[24:27], v234, s[28:31], s71 offen
    buffer_load_dwordx4 v[28:31], v235, s[28:31], s71 offen
    buffer_load_dwordx4 v[32:35], v234, s[28:31], s72 offen
    buffer_load_dwordx4 v[36:39], v235, s[28:31], s72 offen
    buffer_load_dwordx4 v[40:43], v234, s[28:31], s73 offen
    buffer_load_dwordx4 v[44:47], v235, s[28:31], s73 offen
    buffer_load_dwordx4 v[48:51], v234, s[28:31], s74 offen
    buffer_load_dwordx4 v[52:55], v235, s[28:31], s74 offen
    buffer_load_dwordx4 v[56:59], v234, s[28:31], s75 offen
    buffer_load_dwordx4 v[60:63], v235, s[28:31], s75 offen
    buffer_load_dwordx4 v[64:67], v234, s[28:31], s76 offen
    buffer_load_dwordx4 v[68:71], v235, s[28:31], s76 offen
    buffer_load_dwordx4 v[72:75], v234, s[28:31], s77 offen
    buffer_load_dwordx4 v[76:79], v235, s[28:31], s77 offen
feok_12:
L_phase2:
    s_waitcnt vmcnt(14)
    v_mfma_f32_32x32x16_bf16 a[0:15], a[128:131], v[16:19], 0
    ds_read_b64_tr_b16 a[248:249], v12 offset:6144
    ds_read_b64_tr_b16 a[250:251], v12 offset:6656
    v_mfma_f32_32x32x16_bf16 a[16:31], a[132:135], v[16:19], 0
    ds_read_b64_tr_b16 a[252:253], v12 offset:7168
    ds_read_b64_tr_b16 a[254:255], v12 offset:7680
    v_mfma_f32_32x32x16_bf16 a[32:47], a[128:131], v[20:23], 0
    v_mfma_f32_32x32x16_bf16 a[48:63], a[132:135], v[20:23], 0
    v_mov_b32 v244, s44
    v_mov_b32 v245, s45
    v_mov_b32 v246, 14680064
    s_mov_b64 exec, 1
    buffer_store_dwordx2 v[244:245], v246, s[28:31], s41 offen sc1
    s_mov_b64 exec, -1
    s_add_u32 s60, s44, 16
    s_addc_u32 s61, s45, 0
    v_cmp_ne_u64 vcc, s[60:61], v[176:177]
    s_cbranch_vccz f3ok_15
    s_mov_b32 s67, 0x8000
poll_16:
    buffer_load_dwordx2 v[176:177], v241, s[28:31], 0 offen sc1
    s_waitcnt vmcnt(0)
    v_cmp_ne_u64 vcc, s[60:61], v[176:177]
    s_cbranch_vccz polld_17
    s_sub_u32 s67, s67, 1
    s_cmp_lg_u32 s67, 0
    s_cbranch_scc1 poll_16
polld_17:
f3ok_15:
    buffer_load_dwordx4 v[16:19], v234, s[28:31], s78 offen
    buffer_load_dwordx4 v[20:23], v235, s[28:31], s78 offen
    buffer_load_dwordx4 v[96:99], v242, s[28:31], 0 offen offset:0
    buffer_load_dwordx4 v[100:103], v242, s[28:31], 0 offen offset:1024
    buffer_load_dwordx4 v[128:131], v236, s[28:31], 0 offen offset:0
    buffer_load_dwordx4 v[132:135], v237, s[28:31], 0 offen offset:0
    buffer_load_dwordx4 v[104:107], v242, s[28:31], 0 offen offset:2048
    buffer_load_dwordx4 v[108:111], v242, s[28:31], 0 offen offset:3072
    buffer_load_dwordx4 v[136:139], v236, s[28:31], 0 offen offset:1024
    buffer_load_dwordx4 v[140:143], v237, s[28:31], 0 offen offset:1024
    s_waitcnt vmcnt(23)
    v_mfma_f32_32x32x16_bf16 a[0:15], a[136:139], v[24:27], a[0:15]
    v_mfma_f32_32x32x16_bf16 a[16:31], a[140:143], v[24:27], a[16:31]
    s_lshl_b32 s62, s83, 4
    s_add_u32 m0, s3, 6144
    s_waitcnt lgkmcnt(0)
    buffer_load_dwordx4 v254, s[16:19], s62 offen lds
    v_mfma_f32_32x32x16_bf16 a[32:47], a[136:139], v[28:31], a[32:47]
    s_add_u32 m0, s3, 7168
    s_nop 0
    buffer_load_dwordx4 v255, s[16:19], s62 offen lds
    v_mfma_f32_32x32x16_bf16 a[48:63], a[140:143], v[28:31], a[48:63]
    buffer_load_dwordx4 v[24:27], v234, s[28:31], s79 offen
    buffer_load_dwordx4 v[28:31], v235, s[28:31], s79 offen
    s_waitcnt vmcnt(25)
    v_mfma_f32_32x32x16_bf16 a[0:15], a[144:147], v[32:35], a[0:15]
    v_mfma_f32_32x32x16_bf16 a[16:31], a[148:151], v[32:35], a[16:31]
    s_lshl_b32 s62, s84, 4
    s_add_u32 m0, s43, 0
    buffer_load_dwordx4 v254, s[16:19], s62 offen lds
    v_mfma_f32_32x32x16_bf16 a[32:47], a[144:147], v[36:39], a[32:47]
    s_add_u32 m0, s43, 1024
    s_nop 0
    buffer_load_dwordx4 v255, s[16:19], s62 offen lds
    v_mfma_f32_32x32x16_bf16 a[48:63], a[148:151], v[36:39], a[48:63]
    buffer_load_dwordx4 v[32:35], v234, s[28:31], s80 offen
    buffer_load_dwordx4 v[36:39], v235, s[28:31], s80 offen
    v_add_u32 v242, 4096, v242
    buffer_load_dwordx4 v[112:115], v242, s[28:31], 0 offen offset:0
    buffer_load_dwordx4 v[116:119], v242, s[28:31], 0 offen offset:1024
    buffer_load_dwordx4 v[144:147], v236, s[28:31], 0 offen offset:2048
    buffer_load_dwordx4 v[148:151], v237, s[28:31], 0 offen offset:2048
    s_waitcnt vmcnt(31)
    v_mfma_f32_32x32x16_bf16 a[0:15], a[152:155], v[40:43], a[0:15]
    v_mfma_f32_32x32x16_bf16 a[16:31], a[156:159], v[40:43], a[16:31]
    s_lshl_b32 s62, s85, 4
    s_add_u32 m0, s43, 2048
    buffer_load_dwordx4 v254, s[16:19], s62 offen lds
    s_waitcnt vmcnt(19)
    v_cvt_pk_bf16_f32 v96, v96, v97
    v_cvt_pk_bf16_f32 v97, v98, v99
    v_cvt_pk_bf16_f32 v98, v100, v101
    v_cvt_pk_bf16_f32 v99, v102, v103
    s_nop 0
    v_mfma_f32_32x32x16_bf16 a[32:47], a[152:155], v[44:47], a[32:47]
    s_add_u32 m0, s43, 3072
    s_nop 0
    buffer_load_dwordx4 v255, s[16:19], s62 offen lds
    s_waitcnt vmcnt(19)
    v_mfma_f32_32x32x16_bf16 v[192:207], v[96:99], v[128:131], 0
    v_mfma_f32_32x32x16_bf16 a[48:63], a[156:159], v[44:47], a[48:63]
    buffer_load_dwordx4 v[40:43], v234, s[28:31], s81 offen
    buffer_load_dwordx4 v[44:47], v235, s[28:31], s81 offen
    v_mfma_f32_32x32x16_bf16 a[0:15], a[160:163], v[48:51], a[0:15]
    v_add_f32 v200, s66, v200
    v_rcp_f32 v200, v200
    s_nop 0
    v_mul_f32 v192, v192, v200
    s_waitcnt vmcnt(20)
    v_mfma_f32_32x32x16_bf16 v[208:223], v[96:99], v[132:135], 0
    v_mfma_f32_32x32x16_bf16 a[16:31], a[164:167], v[48:51], a[16:31]
    s_lshl_b32 s62, s86, 4
    s_add_u32 m0, s43, 4096
    buffer_load_dwordx4 v254, s[16:19], s62 offen lds
    v_mul_f32 v193, v193, v200
    v_mul_f32 v194, v194, v200
    v_mul_f32 v195, v195, v200
    v_mul_f32 v196, v196, v200
    v_mfma_f32_32x32x16_bf16 a[32:47], a[160:163], v[52:55], a[32:47]
    s_add_u32 m0, s43, 5120
    s_nop 0
    buffer_load_dwordx4 v255, s[16:19], s62 offen lds
    v_mul_f32 v197, v197, v200
    v_mul_f32 v198, v198, v200
    v_mul_f32 v199, v199, v200
    v_cvt_pk_bf16_f32 v128, v192, v193
    v_add_f32 v216, s66, v216
    v_rcp_f32 v216, v216
    s_nop 0
    v_mul_f32 v208, v208, v216
    v_mfma_f32_32x32x16_bf16 a[48:63], a[164:167], v[52:55], a[48:63]
    buffer_load_dwordx4 v[120:123], v242, s[28:31], 0 offen offset:2048
    buffer_load_dwordx4 v[124:127], v242, s[28:31], 0 offen offset:3072
    buffer_load_dwordx4 v[152:155], v236, s[28:31], 0 offen offset:3072
    buffer_load_dwordx4 v[156:159], v237, s[28:31], 0 offen offset:3072
    v_cvt_pk_bf16_f32 v129, v194, v195
    v_cvt_pk_bf16_f32 v130, v196, v197
    v_cvt_pk_bf16_f32 v131, v198, v199
    v_mul_f32 v209, v209, v216
    v_mul_f32 v210, v210, v216
    v_mul_f32 v211, v211, v216
    v_mul_f32 v212, v212, v216
    v_mfma_f32_32x32x16_bf16 a[0:15], a[168:171], v[56:59], a[0:15]
    v_mul_f32 v213, v213, v216
    v_mul_f32 v214, v214, v216
    v_mul_f32 v215, v215, v216
    v_cvt_pk_bf16_f32 v132, v208, v209
    v_mfma_f32_32x32x16_bf16 a[16:31], a[172:175], v[56:59], a[16:31]
    s_lshl_b32 s62, s87, 4
    s_add_u32 m0, s43, 6144
    buffer_load_dwordx4 v254, s[16:19], s62 offen lds
    v_cvt_pk_bf16_f32 v133, v210, v211
    v_cvt_pk_bf16_f32 v134, v212, v213
    v_cvt_pk_bf16_f32 v135, v214, v215
    s_waitcnt vmcnt(25)
    v_cvt_pk_bf16_f32 v104, v104, v105
    v_cvt_pk_bf16_f32 v105, v106, v107
    v_cvt_pk_bf16_f32 v106, v108, v109
    v_cvt_pk_bf16_f32 v107, v110, v111
    s_nop 0
    v_mfma_f32_32x32x16_bf16 a[32:47], a[168:171], v[60:63], a[32:47]
    s_add_u32 m0, s43, 7168
    s_nop 0
    buffer_load_dwordx4 v255, s[16:19], s62 offen lds
    s_waitcnt vmcnt(25)
    v_mfma_f32_32x32x16_bf16 v[192:207], v[104:107], v[136:139], 0
    v_mfma_f32_32x32x16_bf16 a[48:63], a[172:175], v[60:63], a[48:63]
    v_mfma_f32_32x32x16_bf16 a[64:79], a[176:179], v[128:131], 0
    v_add_f32 v192, s66, v192
    v_rcp_f32 v192, v192
    s_nop 0
    v_mul_f32 v200, v200, v192
    s_waitcnt vmcnt(24)
    v_mfma_f32_32x32x16_bf16 v[208:223], v[104:107], v[140:143], 0
    v_mfma_f32_32x32x16_bf16 a[80:95], a[180:183], v[128:131], 0
    s_lshl_b32 s62, s88, 4
    s_add_u32 m0, s43, 8192
    buffer_load_dwordx4 v254, s[16:19], s62 offen lds
    v_mul_f32 v201, v201, v192
    v_mul_f32 v202, v202, v192
    v_mul_f32 v203, v203, v192
    v_mul_f32 v204, v204, v192
    v_mfma_f32_32x32x16_bf16 a[96:111], a[176:179], v[132:135], 0
    s_add_u32 m0, s43, 9216
    s_nop 0
    buffer_load_dwordx4 v255, s[16:19], s62 offen lds
    v_mul_f32 v205, v205, v192
    v_mul_f32 v206, v206, v192
    v_mul_f32 v207, v207, v192
    v_cvt_pk_bf16_f32 v136, v200, v201
    v_add_f32 v208, s66, v208
    v_rcp_f32 v208, v208
    s_nop 0
    v_mul_f32 v216, v216, v208
    v_mfma_f32_32x32x16_bf16 a[112:127], a[180:183], v[132:135], 0
    v_add_u32 v242, 4096, v242
    buffer_load_dwordx4 v[96:99], v242, s[28:31], 0 offen offset:0
    buffer_load_dwordx4 v[100:103], v242, s[28:31], 0 offen offset:1024
    v_add_u32 v236, 4096, v236
    buffer_load_dwordx4 v[160:163], v236, s[28:31], 0 offen offset:0
    v_add_u32 v237, 4096, v237
    buffer_load_dwordx4 v[164:167], v237, s[28:31], 0 offen offset:0
    v_cvt_pk_bf16_f32 v137, v202, v203
    v_cvt_pk_bf16_f32 v138, v204, v205
    v_cvt_pk_bf16_f32 v139, v206, v207
    v_mul_f32 v217, v217, v208
    v_mul_f32 v218, v218, v208
    v_mul_f32 v219, v219, v208
    v_mul_f32 v220, v220, v208
    v_mfma_f32_32x32x16_bf16 a[0:15], a[184:187], v[64:67], a[0:15]
    v_mul_f32 v221, v221, v208
    v_mul_f32 v222, v222, v208
    v_mul_f32 v223, v223, v208
    v_cvt_pk_bf16_f32 v140, v216, v217
    v_mfma_f32_32x32x16_bf16 a[16:31], a[188:191], v[64:67], a[16:31]
    s_lshl_b32 s62, s89, 4
    s_add_u32 m0, s43, 10240
    buffer_load_dwordx4 v254, s[16:19], s62 offen lds
    v_cvt_pk_bf16_f32 v141, v218, v219
    v_cvt_pk_bf16_f32 v142, v220, v221
    v_cvt_pk_bf16_f32 v143, v222, v223
    s_waitcnt vmcnt(21)
    v_cvt_pk_bf16_f32 v112, v112, v113
    v_cvt_pk_bf16_f32 v113, v114, v115
    v_cvt_pk_bf16_f32 v114, v116, v117
    v_cvt_pk_bf16_f32 v115, v118, v119
    s_nop 0
    v_mfma_f32_32x32x16_bf16 a[32:47], a[184:187], v[68:71], a[32:47]
    s_add_u32 m0, s43, 11264
    s_nop 0
    buffer_load_dwordx4 v255, s[16:19], s62 offen lds
    s_waitcnt vmcnt(21)
    v_mfma_f32_32x32x16_bf16 v[192:207], v[112:115], v[144:147], 0
    v_mfma_f32_32x32x16_bf16 a[48:63], a[188:191], v[68:71], a[48:63]
    v_mfma_f32_32x32x16_bf16 a[64:79], a[192:195], v[136:139], a[64:79]
    v_add_f32 v200, s66, v200
    v_rcp_f32 v200, v200
    s_nop 0
    v_mul_f32 v192, v192, v200
    s_waitcnt vmcnt(20)
    v_mfma_f32_32x32x16_bf16 v[208:223], v[112:115], v[148:151], 0
    v_mfma_f32_32x32x16_bf16 a[80:95], a[196:199], v[136:139], a[80:95]
    s_lshl_b32 s62, s90, 4
    s_add_u32 m0, s43, 12288
    buffer_load_dwordx4 v254, s[16:19], s62 offen lds
    v_mul_f32 v193, v193, v200
    v_mul_f32 v194, v194, v200
    v_mul_f32 v195, v195, v200
    v_mul_f32 v196, v196, v200
    v_mfma_f32_32x32x16_bf16 a[96:111], a[192:195], v[140:143], a[96:111]
    s_add_u32 m0, s43, 13312
    s_nop 0
    buffer_load_dwordx4 v255, s[16:19], s62 offen lds
    v_mul_f32 v197, v197, v200
    v_mul_f32 v198, v198, v200
    v_mul_f32 v199, v199, v200
    v_cvt_pk_bf16_f32 v144, v192, v193
    v_add_f32 v216, s66, v216
    v_rcp_f32 v216, v216
    s_nop 0
    v_mul_f32 v208, v208, v216
    v_mfma_f32_32x32x16_bf16 a[112:127], a[196:199], v[140:143], a[112:127]
    buffer_load_dwordx4 v[104:107], v242, s[28:31], 0 offen offset:2048
    buffer_load_dwordx4 v[108:111], v242, s[28:31], 0 offen offset:3072
    buffer_load_dwordx4 v[168:171], v236, s[28:31], 0 offen offset:1024
    buffer_load_dwordx4 v[172:175], v237, s[28:31], 0 offen offset:1024
    v_cvt_pk_bf16_f32 v145, v194, v195
    v_cvt_pk_bf16_f32 v146, v196, v197
    v_cvt_pk_bf16_f32 v147, v198, v199
    v_mul_f32 v209, v209, v216
    v_mul_f32 v210, v210, v216
    v_mul_f32 v211, v211, v216
    v_mul_f32 v212, v212, v216
    v_mfma_f32_32x32x16_bf16 a[0:15], a[200:203], v[72:75], a[0:15]
    v_mul_f32 v213, v213, v216
    v_mul_f32 v214, v214, v216
    v_mul_f32 v215, v215, v216
    v_cvt_pk_bf16_f32 v148, v208, v209
    v_mfma_f32_32x32x16_bf16 a[16:31], a[204:207], v[72:75], a[16:31]
    s_lshl_b32 s62, s91, 4
    s_add_u32 m0, s43, 14336
    buffer_load_dwordx4 v254, s[16:19], s62 offen lds
    v_cvt_pk_bf16_f32 v149, v210, v211
    v_cvt_pk_bf16_f32 v150, v212, v213
    v_cvt_pk_bf16_f32 v151, v214, v215
    s_waitcnt vmcnt(19)
    v_cvt_pk_bf16_f32 v120, v120, v121
    v_cvt_pk_bf16_f32 v121, v122, v123
    v_cvt_pk_bf16_f32 v122, v124, v125
    v_cvt_pk_bf16_f32 v123, v126, v127
    s_nop 0
    v_mfma_f32_32x32x16_bf16 a[32:47], a[200:203], v[76:79], a[32:47]
    s_add_u32 m0, s43, 15360
    s_nop 0
    buffer_load_dwordx4 v255, s[16:19], s62 offen lds
    s_waitcnt vmcnt(19)
    v_mfma_f32_32x32x16_bf16 v[192:207], v[120:123], v[152:155], 0
    v_mfma_f32_32x32x16_bf16 a[48:63], a[204:207], v[76:79], a[48:63]
    v_mfma_f32_32x32x16_bf16 a[64:79], a[208:211], v[144:147], a[64:79]
    v_add_f32 v192, s66, v192
    v_rcp_f32 v192, v192
    s_nop 0
    v_mul_f32 v200, v200, v192
    s_waitcnt vmcnt(18)
    v_mfma_f32_32x32x16_bf16 v[208:223], v[120:123], v[156:159], 0
    v_mfma_f32_32x32x16_bf16 a[80:95], a[212:215], v[144:147], a[80:95]
    s_lshl_b32 s62, s92, 4
    s_add_u32 m0, s43, 16384
    buffer_load_dwordx4 v254, s[16:19], s62 offen lds
    v_mul_f32 v201, v201, v192
    v_mul_f32 v202, v202, v192
    v_mul_f32 v203, v203, v192
    v_mul_f32 v204, v204, v192
    v_mfma_f32_32x32x16_bf16 a[96:111], a[208:211], v[148:151], a[96:111]
    s_add_u32 m0, s43, 17408
    s_nop 0
    buffer_load_dwordx4 v255, s[16:19], s62 offen lds
    v_mul_f32 v205, v205, v192
    v_mul_f32 v206, v206, v192
    v_mul_f32 v207, v207, v192
    v_cvt_pk_bf16_f32 v152, v200, v201
    v_add_f32 v208, s66, v208
    v_rcp_f32 v208, v208
    s_nop 0
    v_mul_f32 v216, v216, v208
    v_mfma_f32_32x32x16_bf16 a[112:127], a[212:215], v[148:151], a[112:127]
    v_add_u32 v242, 4096, v242
    buffer_load_dwordx4 v[112:115], v242, s[28:31], 0 offen offset:0
    buffer_load_dwordx4 v[116:119], v242, s[28:31], 0 offen offset:1024
    buffer_load_dwordx4 v[176:179], v236, s[28:31], 0 offen offset:2048
    buffer_load_dwordx4 v[180:183], v237, s[28:31], 0 offen offset:2048
    v_cvt_pk_bf16_f32 v153, v202, v203
    v_cvt_pk_bf16_f32 v154, v204, v205
    v_cvt_pk_bf16_f32 v155, v206, v207
    v_mul_f32 v217, v217, v208
    v_mul_f32 v218, v218, v208
    v_mul_f32 v219, v219, v208
    v_mul_f32 v220, v220, v208
    v_mfma_f32_32x32x16_bf16 a[0:15], a[216:219], v[16:19], a[0:15]
    v_mul_f32 v221, v221, v208
    v_mul_f32 v222, v222, v208
    v_mul_f32 v223, v223, v208
    v_cvt_pk_bf16_f32 v156, v216, v217
    v_mfma_f32_32x32x16_bf16 a[16:31], a[220:223], v[16:19], a[16:31]
    s_lshl_b32 s62, s93, 4
    s_add_u32 m0, s43, 18432
    buffer_load_dwordx4 v254, s[16:19], s62 offen lds
    v_cvt_pk_bf16_f32 v157, v218, v219
    v_cvt_pk_bf16_f32 v158, v220, v221
    v_cvt_pk_bf16_f32 v159, v222, v223
    s_waitcnt vmcnt(19)
    v_cvt_pk_bf16_f32 v96, v96, v97
    v_cvt_pk_bf16_f32 v97, v98, v99
    v_cvt_pk_bf16_f32 v98, v100, v101
    v_cvt_pk_bf16_f32 v99, v102, v103
    s_nop 0
    v_mfma_f32_32x32x16_bf16 a[32:47], a[216:219], v[20:23], a[32:47]
    s_add_u32 m0, s43, 19456
    s_nop 0
    buffer_load_dwordx4 v255, s[16:19], s62 offen lds
    s_waitcnt vmcnt(19)
    v_mfma_f32_32x32x16_bf16 v[192:207], v[96:99], v[160:163], 0
    v_mfma_f32_32x32x16_bf16 a[48:63], a[220:223], v[20:23], a[48:63]
    v_mfma_f32_32x32x16_bf16 a[64:79], a[224:227], v[152:155], a[64:79]
    v_add_f32 v200, s66, v200
    v_rcp_f32 v200, v200
    s_nop 0
    v_mul_f32 v192, v192, v200
    s_waitcnt vmcnt(18)
    v_mfma_f32_32x32x16_bf16 v[208:223], v[96:99], v[164:167], 0
    v_mfma_f32_32x32x16_bf16 a[80:95], a[228:231], v[152:155], a[80:95]
    s_lshl_b32 s62, s94, 4
    s_add_u32 m0, s43, 20480
    buffer_load_dwordx4 v254, s[16:19], s62 offen lds
    v_mul_f32 v193, v193, v200
    v_mul_f32 v194, v194, v200
    v_mul_f32 v195, v195, v200
    v_mul_f32 v196, v196, v200
    v_mfma_f32_32x32x16_bf16 a[96:111], a[224:227], v[156:159], a[96:111]
    s_add_u32 m0, s43, 21504
    s_nop 0
    buffer_load_dwordx4 v255, s[16:19], s62 offen lds
    v_mul_f32 v197, v197, v200
    v_mul_f32 v198, v198, v200
    v_mul_f32 v199, v199, v200
    v_cvt_pk_bf16_f32 v160, v192, v193
    v_add_f32 v216, s66, v216
    v_rcp_f32 v216, v216
    s_nop 0
    v_mul_f32 v208, v208, v216
    v_mfma_f32_32x32x16_bf16 a[112:127], a[228:231], v[156:159], a[112:127]
    buffer_load_dwordx2 v[228:229], v240, s[28:31], 0 offen sc1
    buffer_load_dwordx4 v[120:123], v242, s[28:31], 0 offen offset:2048
    buffer_load_dwordx4 v[124:127], v242, s[28:31], 0 offen offset:3072
    buffer_load_dwordx4 v[184:187], v236, s[28:31], 0 offen offset:3072
    buffer_load_dwordx4 v[188:191], v237, s[28:31], 0 offen offset:3072
    v_cvt_pk_bf16_f32 v161, v194, v195
    v_cvt_pk_bf16_f32 v162, v196, v197
    v_cvt_pk_bf16_f32 v163, v198, v199
    v_mul_f32 v209, v209, v216
    v_mul_f32 v210, v210, v216
    v_mul_f32 v211, v211, v216
    v_mul_f32 v212, v212, v216
    v_mfma_f32_32x32x16_bf16 a[0:15], a[232:235], v[24:27], a[0:15]
    v_mul_f32 v213, v213, v216
    v_mul_f32 v214, v214, v216
    v_mul_f32 v215, v215, v216
    v_cvt_pk_bf16_f32 v164, v208, v209
    v_mfma_f32_32x32x16_bf16 a[16:31], a[236:239], v[24:27], a[16:31]
    s_lshl_b32 s62, s95, 4
    s_add_u32 m0, s43, 22528
    buffer_load_dwordx4 v254, s[16:19], s62 offen lds
    v_cvt_pk_bf16_f32 v165, v210, v211
    v_cvt_pk_bf16_f32 v166, v212, v213
    v_cvt_pk_bf16_f32 v167, v214, v215
    s_waitcnt vmcnt(20)
    v_cvt_pk_bf16_f32 v104, v104, v105
    v_cvt_pk_bf16_f32 v105, v106, v107
    v_cvt_pk_bf16_f32 v106, v108, v109
    v_cvt_pk_bf16_f32 v107, v110, v111
    s_nop 0
    v_mfma_f32_32x32x16_bf16 a[32:47], a[232:235], v[28:31], a[32:47]
    s_add_u32 m0, s43, 23552
    s_nop 0
    buffer_load_dwordx4 v255, s[16:19], s62 offen lds
    s_waitcnt vmcnt(20)
    v_mfma_f32_32x32x16_bf16 v[192:207], v[104:107], v[168:171], 0
    v_mfma_f32_32x32x16_bf16 a[48:63], a[236:239], v[28:31], a[48:63]
    v_mfma_f32_32x32x16_bf16 a[64:79], a[240:243], v[160:163], a[64:79]
    v_add_f32 v192, s66, v192
    v_rcp_f32 v192, v192
    s_nop 0
    v_mul_f32 v200, v200, v192
    s_waitcnt vmcnt(19)
    v_mfma_f32_32x32x16_bf16 v[208:223], v[104:107], v[172:175], 0
    v_mfma_f32_32x32x16_bf16 a[80:95], a[244:247], v[160:163], a[80:95]
    v_mul_f32 v201, v201, v192
    v_mul_f32 v202, v202, v192
    v_mul_f32 v203, v203, v192
    v_mul_f32 v204, v204, v192
    v_mfma_f32_32x32x16_bf16 a[96:111], a[240:243], v[164:167], a[96:111]
    v_mul_f32 v205, v205, v192
    v_mul_f32 v206, v206, v192
    v_mul_f32 v207, v207, v192
    v_cvt_pk_bf16_f32 v168, v200, v201
    v_add_f32 v208, s66, v208
    v_rcp_f32 v208, v208
    s_nop 0
    v_mul_f32 v216, v216, v208
    v_mfma_f32_32x32x16_bf16 a[112:127], a[244:247], v[164:167], a[112:127]
    s_waitcnt vmcnt(6)
    v_cmp_ne_u64 vcc, s[44:45], v[228:229]
    s_cbranch_vccz f1ok_18
    s_mov_b32 s67, 0x8000
poll_19:
    buffer_load_dwordx2 v[228:229], v240, s[28:31], 0 offen sc1
    s_waitcnt vmcnt(0)
    v_cmp_ne_u64 vcc, s[44:45], v[228:229]
    s_cbranch_vccz polld_20
    s_sub_u32 s67, s67, 1
    s_cmp_lg_u32 s67, 0
    s_cbranch_scc1 poll_19
polld_20:
f1ok_18:
    buffer_load_dwordx4 v[48:51], v234, s[28:31], s82 offen
    buffer_load_dwordx4 v[52:55], v235, s[28:31], s82 offen
    v_cvt_pk_bf16_f32 v169, v202, v203
    v_cvt_pk_bf16_f32 v170, v204, v205
    v_cvt_pk_bf16_f32 v171, v206, v207
    v_mul_f32 v217, v217, v208
    v_mul_f32 v218, v218, v208
    v_mul_f32 v219, v219, v208
    v_mul_f32 v220, v220, v208
    v_mfma_f32_32x32x16_bf16 a[0:15], a[248:251], v[32:35], a[0:15]
    ds_read_b64_tr_b16 v[80:81], v12 offset:8192
    ds_read_b64_tr_b16 v[82:83], v12 offset:8704
    v_mul_f32 v221, v221, v208
    v_mul_f32 v222, v222, v208
    v_mul_f32 v223, v223, v208
    v_cvt_pk_bf16_f32 v172, v216, v217
    v_mfma_f32_32x32x16_bf16 a[16:31], a[252:255], v[32:35], a[16:31]
    ds_read_b64_tr_b16 v[84:85], v12 offset:9216
    ds_read_b64_tr_b16 v[86:87], v12 offset:9728
    v_cvt_pk_bf16_f32 v173, v218, v219
    v_cvt_pk_bf16_f32 v174, v220, v221
    v_cvt_pk_bf16_f32 v175, v222, v223
    v_cvt_pk_bf16_f32 v112, v112, v113
    v_cvt_pk_bf16_f32 v113, v114, v115
    v_cvt_pk_bf16_f32 v114, v116, v117
    v_cvt_pk_bf16_f32 v115, v118, v119
    s_nop 0
    v_mfma_f32_32x32x16_bf16 a[32:47], a[248:251], v[36:39], a[32:47]
    v_mfma_f32_32x32x16_bf16 v[192:207], v[112:115], v[176:179], 0
    v_mfma_f32_32x32x16_bf16 a[48:63], a[252:255], v[36:39], a[48:63]
    buffer_load_dwordx4 v[56:59], v234, s[28:31], s83 offen
    buffer_load_dwordx4 v[60:63], v235, s[28:31], s83 offen
    s_waitcnt lgkmcnt(0)
    v_mfma_f32_32x32x16_bf16 a[64:79], v[80:83], v[168:171], a[64:79]
    ds_read_b64_tr_b16 v[88:89], v12 offset:10240
    ds_read_b64_tr_b16 v[90:91], v12 offset:10752
    v_add_f32 v200, s66, v200
    v_rcp_f32 v200, v200
    s_nop 0
    v_mul_f32 v192, v192, v200
    v_mfma_f32_32x32x16_bf16 v[208:223], v[112:115], v[180:183], 0
    v_mfma_f32_32x32x16_bf16 a[80:95], v[84:87], v[168:171], a[80:95]
    ds_read_b64_tr_b16 v[92:93], v12 offset:11264
    ds_read_b64_tr_b16 v[94:95], v12 offset:11776
    v_mul_f32 v193, v193, v200
    v_mul_f32 v194, v194, v200
    v_mul_f32 v195, v195, v200
    v_mul_f32 v196, v196, v200
    v_mfma_f32_32x32x16_bf16 a[96:111], v[80:83], v[172:175], a[96:111]
    v_mul_f32 v197, v197, v200
    v_mul_f32 v198, v198, v200
    v_mul_f32 v199, v199, v200
    v_cvt_pk_bf16_f32 v176, v192, v193
    v_add_f32 v216, s66, v216
    v_rcp_f32 v216, v216
    s_nop 0
    v_mul_f32 v208, v208, v216
    v_mfma_f32_32x32x16_bf16 a[112:127], v[84:87], v[172:175], a[112:127]
    buffer_load_dwordx4 v[64:67], v234, s[28:31], s84 offen
    buffer_load_dwordx4 v[68:71], v235, s[28:31], s84 offen
    v_cvt_pk_bf16_f32 v177, v194, v195
    v_cvt_pk_bf16_f32 v178, v196, v197
    v_cvt_pk_bf16_f32 v179, v198, v199
    v_mul_f32 v209, v209, v216
    v_mul_f32 v210, v210, v216
    v_mul_f32 v211, v211, v216
    v_mul_f32 v212, v212, v216
    s_waitcnt lgkmcnt(0)
    v_mfma_f32_32x32x16_bf16 a[0:15], v[88:91], v[40:43], a[0:15]
    ds_read_b64_tr_b16 v[80:81], v12 offset:0
    ds_read_b64_tr_b16 v[82:83], v12 offset:512
    v_mul_f32 v213, v213, v216
    v_mul_f32 v214, v214, v216
    v_mul_f32 v215, v215, v216
    v_cvt_pk_bf16_f32 v180, v208, v209
    v_mfma_f32_32x32x16_bf16 a[16:31], v[92:95], v[40:43], a[16:31]
    ds_read_b64_tr_b16 v[84:85], v12 offset:1024
    ds_read_b64_tr_b16 v[86:87], v12 offset:1536
    v_cvt_pk_bf16_f32 v181, v210, v211
    v_cvt_pk_bf16_f32 v182, v212, v213
    v_cvt_pk_bf16_f32 v183, v214, v215
    s_waitcnt vmcnt(10)
    v_cvt_pk_bf16_f32 v120, v120, v121
    v_cvt_pk_bf16_f32 v121, v122, v123
    v_cvt_pk_bf16_f32 v122, v124, v125
    v_cvt_pk_bf16_f32 v123, v126, v127
    s_nop 0
    v_mfma_f32_32x32x16_bf16 a[32:47], v[88:91], v[44:47], a[32:47]
    s_waitcnt vmcnt(9)
    v_mfma_f32_32x32x16_bf16 v[192:207], v[120:123], v[184:187], 0
    v_mfma_f32_32x32x16_bf16 a[48:63], v[92:95], v[44:47], a[48:63]
    buffer_load_dwordx4 v[72:75], v234, s[28:31], s85 offen
    buffer_load_dwordx4 v[76:79], v235, s[28:31], s85 offen
    s_waitcnt lgkmcnt(0)
    v_mfma_f32_32x32x16_bf16 a[64:79], v[80:83], v[176:179], a[64:79]
    ds_read_b64_tr_b16 v[88:89], v12 offset:2048
    ds_read_b64_tr_b16 v[90:91], v12 offset:2560
    v_add_f32 v192, s66, v192
    v_rcp_f32 v192, v192
    s_nop 0
    v_mul_f32 v200, v200, v192
    s_waitcnt vmcnt(10)
    v_mfma_f32_32x32x16_bf16 v[208:223], v[120:123], v[188:191], 0
    v_mfma_f32_32x32x16_bf16 a[80:95], v[84:87], v[176:179], a[80:95]
    ds_read_b64_tr_b16 v[92:93], v12 offset:3072
    ds_read_b64_tr_b16 v[94:95], v12 offset:3584
    v_mul_f32 v201, v201, v192
    v_mul_f32 v202, v202, v192
    v_mul_f32 v203, v203, v192
    v_mul_f32 v204, v204, v192
    v_mfma_f32_32x32x16_bf16 a[96:111], v[80:83], v[180:183], a[96:111]
    v_mul_f32 v205, v205, v192
    v_mul_f32 v206, v206, v192
    v_mul_f32 v207, v207, v192
    v_cvt_pk_bf16_f32 v184, v200, v201
    v_add_f32 v208, s66, v208
    v_rcp_f32 v208, v208
    s_nop 0
    v_mul_f32 v216, v216, v208
    v_mfma_f32_32x32x16_bf16 a[112:127], v[84:87], v[180:183], a[112:127]
    buffer_load_dwordx4 v[16:19], v234, s[28:31], s86 offen
    buffer_load_dwordx4 v[20:23], v235, s[28:31], s86 offen
    v_cvt_pk_bf16_f32 v185, v202, v203
    v_cvt_pk_bf16_f32 v186, v204, v205
    v_cvt_pk_bf16_f32 v187, v206, v207
    v_mul_f32 v217, v217, v208
    v_mul_f32 v218, v218, v208
    v_mul_f32 v219, v219, v208
    v_mul_f32 v220, v220, v208
    s_waitcnt vmcnt(8) lgkmcnt(0)
    v_mfma_f32_32x32x16_bf16 a[0:15], v[88:91], v[48:51], a[0:15]
    ds_read_b64_tr_b16 v[80:81], v12 offset:4096
    ds_read_b64_tr_b16 v[82:83], v12 offset:4608
    v_mul_f32 v221, v221, v208
    v_mul_f32 v222, v222, v208
    v_mul_f32 v223, v223, v208
    v_cvt_pk_bf16_f32 v188, v216, v217
    v_mfma_f32_32x32x16_bf16 a[16:31], v[92:95], v[48:51], a[16:31]
    ds_read_b64_tr_b16 v[84:85], v12 offset:5120
    ds_read_b64_tr_b16 v[86:87], v12 offset:5632
    v_cvt_pk_bf16_f32 v189, v218, v219
    v_cvt_pk_bf16_f32 v190, v220, v221
    v_cvt_pk_bf16_f32 v191, v222, v223
    v_mfma_f32_32x32x16_bf16 a[32:47], v[88:91], v[52:55], a[32:47]
    v_mfma_f32_32x32x16_bf16 a[48:63], v[92:95], v[52:55], a[48:63]
    buffer_load_dwordx4 v[24:27], v234, s[28:31], s87 offen
    buffer_load_dwordx4 v[28:31], v235, s[28:31], s87 offen
    s_waitcnt lgkmcnt(0)
    v_mfma_f32_32x32x16_bf16 a[64:79], v[80:83], v[184:187], a[64:79]
    ds_read_b64_tr_b16 v[88:89], v12 offset:6144
    ds_read_b64_tr_b16 v[90:91], v12 offset:6656
    v_mfma_f32_32x32x16_bf16 a[80:95], v[84:87], v[184:187], a[80:95]
    ds_read_b64_tr_b16 v[92:93], v12 offset:7168
    ds_read_b64_tr_b16 v[94:95], v12 offset:7680
    v_mfma_f32_32x32x16_bf16 a[96:111], v[80:83], v[188:191], a[96:111]
    v_mfma_f32_32x32x16_bf16 a[112:127], v[84:87], v[188:191], a[112:127]
    buffer_load_dwordx4 v[32:35], v234, s[28:31], s88 offen
    buffer_load_dwordx4 v[36:39], v235, s[28:31], s88 offen
    v_lshlrev_b32 v9, 4, v1
    v_add_u32 v10, s3, v9
    s_waitcnt vmcnt(10) lgkmcnt(0)
    v_mfma_f32_32x32x16_bf16 a[0:15], v[88:91], v[56:59], a[0:15]
    ds_read_b64_tr_b16 v[80:81], v238 offset:0
    ds_read_b64_tr_b16 v[82:83], v238 offset:512
    v_mfma_f32_32x32x16_bf16 a[16:31], v[92:95], v[56:59], a[16:31]
    ds_read_b64_tr_b16 v[84:85], v238 offset:1024
    ds_read_b64_tr_b16 v[86:87], v238 offset:1536
    v_mfma_f32_32x32x16_bf16 a[32:47], v[88:91], v[60:63], a[32:47]
    v_mfma_f32_32x32x16_bf16 a[48:63], v[92:95], v[60:63], a[48:63]
    buffer_load_dwordx4 v[40:43], v234, s[28:31], s89 offen
    buffer_load_dwordx4 v[44:47], v235, s[28:31], s89 offen
    s_xor_b32 s56, s36, 1
    s_mul_i32 s56, s56, 12288
    s_add_u32 s56, s56, 98304
    v_add_u32 v5, s56, v9
    s_xor_b32 s56, s36, 2
    s_mul_i32 s56, s56, 12288
    s_add_u32 s56, s56, 98304
    v_add_u32 v6, s56, v9
    s_xor_b32 s56, s36, 3
    s_mul_i32 s56, s56, 12288
    s_add_u32 s56, s56, 98304
    v_add_u32 v7, s56, v9
    s_waitcnt vmcnt(10) lgkmcnt(0)
    v_mfma_f32_32x32x16_bf16 a[0:15], v[80:83], v[64:67], a[0:15]
    ds_read_b64_tr_b16 v[88:89], v238 offset:2048
    ds_read_b64_tr_b16 v[90:91], v238 offset:2560
    v_mfma_f32_32x32x16_bf16 a[16:31], v[84:87], v[64:67], a[16:31]
    ds_read_b64_tr_b16 v[92:93], v238 offset:3072
    ds_read_b64_tr_b16 v[94:95], v238 offset:3584
    ds_write_b128 v10, a[80:83] offset:0
    v_mfma_f32_32x32x16_bf16 a[32:47], v[80:83], v[68:71], a[32:47]
    v_mfma_f32_32x32x16_bf16 a[48:63], v[84:87], v[68:71], a[48:63]
    buffer_load_dwordx4 v[48:51], v234, s[28:31], s90 offen
    buffer_load_dwordx4 v[52:55], v235, s[28:31], s90 offen
    ds_write_b128 v10, a[84:87] offset:1024
    s_waitcnt vmcnt(10) lgkmcnt(2)
    v_mfma_f32_32x32x16_bf16 a[0:15], v[88:91], v[72:75], a[0:15]
    ds_read_b64_tr_b16 v[80:81], v238 offset:4096
    ds_read_b64_tr_b16 v[82:83], v238 offset:4608
    v_mfma_f32_32x32x16_bf16 a[16:31], v[92:95], v[72:75], a[16:31]
    ds_read_b64_tr_b16 v[84:85], v238 offset:5120
    ds_read_b64_tr_b16 v[86:87], v238 offset:5632
    ds_write_b128 v10, a[88:91] offset:2048
    v_mfma_f32_32x32x16_bf16 a[32:47], v[88:91], v[76:79], a[32:47]
    v_mfma_f32_32x32x16_bf16 a[48:63], v[92:95], v[76:79], a[48:63]
    buffer_load_dwordx4 v[56:59], v234, s[28:31], s91 offen
    buffer_load_dwordx4 v[60:63], v235, s[28:31], s91 offen
    ds_write_b128 v10, a[92:95] offset:3072
    s_waitcnt vmcnt(10) lgkmcnt(2)
    v_mfma_f32_32x32x16_bf16 a[0:15], v[80:83], v[16:19], a[0:15]
    ds_read_b64_tr_b16 v[88:89], v238 offset:6144
    ds_read_b64_tr_b16 v[90:91], v238 offset:6656
    v_mfma_f32_32x32x16_bf16 a[16:31], v[84:87], v[16:19], a[16:31]
    s_lshl_b32 s62, s96, 4
    s_add_u32 m0, s43, 0
    ds_read_b64_tr_b16 v[92:93], v238 offset:7168
    ds_read_b64_tr_b16 v[94:95], v238 offset:7680
    buffer_load_dwordx4 v254, s[16:19], s62 offen lds
    ds_write_b128 v10, a[96:99] offset:4096
    v_mfma_f32_32x32x16_bf16 a[32:47], v[80:83], v[20:23], a[32:47]
    s_add_u32 m0, s43, 1024
    s_nop 0
    buffer_load_dwordx4 v255, s[16:19], s62 offen lds
    v_mfma_f32_32x32x16_bf16 a[48:63], v[84:87], v[20:23], a[48:63]
    buffer_load_dwordx4 v[64:67], v234, s[28:31], s92 offen
    buffer_load_dwordx4 v[68:71], v235, s[28:31], s92 offen
    buffer_load_dwordx2 v[244:245], v239, s[4:7], 0 offen offset:0
    buffer_load_dwordx2 v[246:247], v239, s[4:7], 0 offen offset:16
    buffer_load_dwordx2 v[248:249], v239, s[4:7], 0 offen offset:32
    buffer_load_dwordx2 v[250:251], v239, s[4:7], 0 offen offset:48
    buffer_load_dword v252, v253, s[28:31], 0 offen
    ds_write_b128 v10, a[100:103] offset:5120
    s_waitcnt vmcnt(17) lgkmcnt(2)
    v_mfma_f32_32x32x16_bf16 a[0:15], v[88:91], v[24:27], a[0:15]
    ds_read_b64_tr_b16 v[80:81], v238 offset:8192
    ds_read_b64_tr_b16 v[82:83], v238 offset:8704
    v_mfma_f32_32x32x16_bf16 a[16:31], v[92:95], v[24:27], a[16:31]
    s_lshl_b32 s62, s97, 4
    s_add_u32 m0, s43, 2048
    ds_read_b64_tr_b16 v[84:85], v238 offset:9216
    ds_read_b64_tr_b16 v[86:87], v238 offset:9728
    buffer_load_dwordx4 v254, s[16:19], s62 offen lds
    ds_write_b128 v10, a[104:107] offset:6144
    v_mfma_f32_32x32x16_bf16 a[32:47], v[88:91], v[28:31], a[32:47]
    s_add_u32 m0, s43, 3072
    s_nop 0
    buffer_load_dwordx4 v255, s[16:19], s62 offen lds
    v_mfma_f32_32x32x16_bf16 a[48:63], v[92:95], v[28:31], a[48:63]
    buffer_load_dwordx4 v[72:75], v234, s[28:31], s93 offen
    buffer_load_dwordx4 v[76:79], v235, s[28:31], s93 offen
    ds_write_b128 v10, a[108:111] offset:7168
    s_waitcnt vmcnt(19) lgkmcnt(2)
    v_mfma_f32_32x32x16_bf16 a[0:15], v[80:83], v[32:35], a[0:15]
    ds_read_b64_tr_b16 v[88:89], v238 offset:10240
    ds_read_b64_tr_b16 v[90:91], v238 offset:10752
    v_accvgpr_read_b32 v128, a64
    v_accvgpr_read_b32 v129, a65
    v_mfma_f32_32x32x16_bf16 a[16:31], v[84:87], v[32:35], a[16:31]
    ds_read_b64_tr_b16 v[92:93], v238 offset:11264
    ds_read_b64_tr_b16 v[94:95], v238 offset:11776
    ds_write_b128 v10, a[112:115] offset:8192
    v_accvgpr_read_b32 v130, a66
    v_accvgpr_read_b32 v131, a67
    v_mfma_f32_32x32x16_bf16 a[32:47], v[80:83], v[36:39], a[32:47]
    v_accvgpr_read_b32 v132, a68
    v_accvgpr_read_b32 v133, a69
    v_mfma_f32_32x32x16_bf16 a[48:63], v[84:87], v[36:39], a[48:63]
    buffer_load_dwordx4 v[16:19], v234, s[28:31], s94 offen
    buffer_load_dwordx4 v[20:23], v235, s[28:31], s94 offen
    ds_write_b128 v10, a[116:119] offset:9216
    v_accvgpr_read_b32 v134, a70
    v_accvgpr_read_b32 v135, a71
    s_waitcnt vmcnt(19) lgkmcnt(2)
    v_mfma_f32_32x32x16_bf16 a[0:15], v[88:91], v[40:43], a[0:15]
    ds_read_b64_tr_b16 v[80:81], v238 offset:12288
    ds_read_b64_tr_b16 v[82:83], v238 offset:12800
    v_accvgpr_read_b32 v136, a72
    v_accvgpr_read_b32 v137, a73
    v_mfma_f32_32x32x16_bf16 a[16:31], v[92:95], v[40:43], a[16:31]
    ds_read_b64_tr_b16 v[84:85], v238 offset:13312
    ds_read_b64_tr_b16 v[86:87], v238 offset:13824
    ds_write_b128 v10, a[120:123] offset:10240
    v_accvgpr_read_b32 v138, a74
    v_accvgpr_read_b32 v139, a75
    v_mfma_f32_32x32x16_bf16 a[32:47], v[88:91], v[44:47], a[32:47]
    v_accvgpr_read_b32 v140, a76
    v_accvgpr_read_b32 v141, a77
    v_mfma_f32_32x32x16_bf16 a[48:63], v[92:95], v[44:47], a[48:63]
    buffer_load_dwordx4 v[24:27], v234, s[28:31], s95 offen
    buffer_load_dwordx4 v[28:31], v235, s[28:31], s95 offen
    ds_write_b128 v10, a[124:127] offset:11264
    v_accvgpr_read_b32 v142, a78
    v_accvgpr_read_b32 v143, a79
    s_waitcnt vmcnt(19) lgkmcnt(2)
    v_mfma_f32_32x32x16_bf16 a[0:15], v[80:83], v[48:51], a[0:15]
    ds_read_b64_tr_b16 v[88:89], v238 offset:14336
    ds_read_b64_tr_b16 v[90:91], v238 offset:14848
    v_mfma_f32_32x32x16_bf16 a[16:31], v[84:87], v[48:51], a[16:31]
    ds_read_b64_tr_b16 v[92:93], v238 offset:15360
    ds_read_b64_tr_b16 v[94:95], v238 offset:15872
    v_mfma_f32_32x32x16_bf16 a[32:47], v[80:83], v[52:55], a[32:47]
    v_mfma_f32_32x32x16_bf16 a[48:63], v[84:87], v[52:55], a[48:63]
    buffer_load_dwordx4 v[32:35], v234, s[28:31], s96 offen
    buffer_load_dwordx4 v[36:39], v235, s[28:31], s96 offen
    s_waitcnt vmcnt(19) lgkmcnt(0)
    v_mfma_f32_32x32x16_bf16 a[0:15], v[88:91], v[56:59], a[0:15]
    ds_read_b64_tr_b16 v[80:81], v238 offset:16384
    ds_read_b64_tr_b16 v[82:83], v238 offset:16896
    s_barrier
    v_mfma_f32_32x32x16_bf16 a[16:31], v[92:95], v[56:59], a[16:31]
    ds_read_b64_tr_b16 v[84:85], v238 offset:17408
    ds_read_b64_tr_b16 v[86:87], v238 offset:17920
    ds_read_b128 v[144:147], v5 offset:0
    ds_read_b128 v[160:163], v6 offset:4096
    ds_read_b128 v[176:179], v7 offset:8192
    ds_read_b128 v[148:151], v5 offset:1024
    v_mfma_f32_32x32x16_bf16 a[32:47], v[88:91], v[60:63], a[32:47]
    ds_read_b128 v[164:167], v6 offset:5120
    ds_read_b128 v[180:183], v7 offset:9216
    ds_read_b128 v[152:155], v5 offset:2048
    v_mfma_f32_32x32x16_bf16 a[48:63], v[92:95], v[60:63], a[48:63]
    buffer_load_dwordx4 v[40:43], v234, s[28:31], s97 offen
    buffer_load_dwordx4 v[44:47], v235, s[28:31], s97 offen
    ds_read_b128 v[168:171], v6 offset:6144
    ds_read_b128 v[184:187], v7 offset:10240
    ds_read_b128 v[156:159], v5 offset:3072
    s_waitcnt vmcnt(17) lgkmcnt(10)
    v_mfma_f32_32x32x16_bf16 a[0:15], v[80:83], v[64:67], a[0:15]
    ds_read_b64_tr_b16 v[88:89], v238 offset:18432
    ds_read_b64_tr_b16 v[90:91], v238 offset:18944
    ds_read_b128 v[172:175], v6 offset:7168
    ds_read_b128 v[188:191], v7 offset:11264
    s_waitcnt vmcnt(12)
    v_mfma_f32_32x32x16_bf16 a[16:31], v[84:87], v[64:67], a[16:31]
    ds_read_b64_tr_b16 v[92:93], v238 offset:19456
    ds_read_b64_tr_b16 v[94:95], v238 offset:19968
    v_lshlrev_b32 v96, 16, v244
    v_and_b32 v97, s69, v244
    v_lshlrev_b32 v98, 16, v245
    v_mfma_f32_32x32x16_bf16 a[32:47], v[80:83], v[68:71], a[32:47]
    v_and_b32 v99, s69, v245
    v_lshlrev_b32 v100, 16, v246
    v_and_b32 v101, s69, v246
    v_mfma_f32_32x32x16_bf16 a[48:63], v[84:87], v[68:71], a[48:63]
    v_lshlrev_b32 v102, 16, v247
    v_and_b32 v103, s69, v247
    v_lshlrev_b32 v104, 16, v248
    s_waitcnt vmcnt(8) lgkmcnt(0)
    v_mfma_f32_32x32x16_bf16 a[0:15], v[88:91], v[72:75], a[0:15]
    ds_read_b64_tr_b16 v[80:81], v238 offset:20480
    ds_read_b64_tr_b16 v[82:83], v238 offset:20992
    v_and_b32 v105, s69, v248
    v_lshlrev_b32 v106, 16, v249
    v_and_b32 v107, s69, v249
    v_mfma_f32_32x32x16_bf16 a[16:31], v[92:95], v[72:75], a[16:31]
    ds_read_b64_tr_b16 v[84:85], v238 offset:21504
    ds_read_b64_tr_b16 v[86:87], v238 offset:22016
    v_lshlrev_b32 v108, 16, v250
    v_and_b32 v109, s69, v250
    v_lshlrev_b32 v110, 16, v251
    v_mfma_f32_32x32x16_bf16 a[32:47], v[88:91], v[76:79], a[32:47]
    v_and_b32 v111, s69, v251
    v_mul_f32 v250, 0xbfb8aa3b, v252
    v_mfma_f32_32x32x16_bf16 a[48:63], v[92:95], v[76:79], a[48:63]
    v_pk_add_f32 v[128:129], v[128:129], v[144:145]
    v_pk_add_f32 v[130:131], v[130:131], v[146:147]
    v_pk_add_f32 v[160:161], v[160:161], v[176:177]
    s_waitcnt vmcnt(6) lgkmcnt(0)
    v_mfma_f32_32x32x16_bf16 a[0:15], v[80:83], v[16:19], a[0:15]
    ds_read_b64_tr_b16 v[88:89], v238 offset:22528
    ds_read_b64_tr_b16 v[90:91], v238 offset:23040
    v_pk_add_f32 v[162:163], v[162:163], v[178:179]
    v_pk_add_f32 v[128:129], v[128:129], v[160:161]
    v_pk_add_f32 v[130:131], v[130:131], v[162:163]
    v_mfma_f32_32x32x16_bf16 a[16:31], v[84:87], v[16:19], a[16:31]
    ds_read_b64_tr_b16 v[92:93], v238 offset:23552
    ds_read_b64_tr_b16 v[94:95], v238 offset:24064
    v_pk_mul_f32 v[128:129], v[128:129], v[252:253] op_sel_hi:[1,0]
    v_pk_mul_f32 v[130:131], v[130:131], v[252:253] op_sel_hi:[1,0]
    v_pk_add_f32 v[132:133], v[132:133], v[148:149]
    v_mfma_f32_32x32x16_bf16 a[32:47], v[80:83], v[20:23], a[32:47]
    v_pk_add_f32 v[134:135], v[134:135], v[150:151]
    v_pk_add_f32 v[164:165], v[164:165], v[180:181]
    v_pk_add_f32 v[166:167], v[166:167], v[182:183]
    v_mfma_f32_32x32x16_bf16 a[48:63], v[84:87], v[20:23], a[48:63]
    v_pk_add_f32 v[132:133], v[132:133], v[164:165]
    v_pk_add_f32 v[134:135], v[134:135], v[166:167]
    v_pk_mul_f32 v[132:133], v[132:133], v[252:253] op_sel_hi:[1,0]
    s_waitcnt vmcnt(4) lgkmcnt(0)
    v_mfma_f32_32x32x16_bf16 a[0:15], v[88:91], v[24:27], a[0:15]
    ds_read_b64_tr_b16 v[80:81], v238 offset:0
    ds_read_b64_tr_b16 v[82:83], v238 offset:512
    v_pk_mul_f32 v[134:135], v[134:135], v[252:253] op_sel_hi:[1,0]
    v_pk_add_f32 v[136:137], v[136:137], v[152:153]
    v_mfma_f32_32x32x16_bf16 a[16:31], v[92:95], v[24:27], a[16:31]
    ds_read_b64_tr_b16 v[84:85], v238 offset:1024
    ds_read_b64_tr_b16 v[86:87], v238 offset:1536
    v_pk_add_f32 v[138:139], v[138:139], v[154:155]
    v_pk_add_f32 v[168:169], v[168:169], v[184:185]
    v_pk_add_f32 v[170:171], v[170:171], v[186:187]
    v_mfma_f32_32x32x16_bf16 a[32:47], v[88:91], v[28:31], a[32:47]
    v_pk_add_f32 v[136:137], v[136:137], v[168:169]
    v_pk_add_f32 v[138:139], v[138:139], v[170:171]
    v_pk_mul_f32 v[136:137], v[136:137], v[252:253] op_sel_hi:[1,0]
    v_mfma_f32_32x32x16_bf16 a[48:63], v[92:95], v[28:31], a[48:63]
    v_pk_mul_f32 v[138:139], v[138:139], v[252:253] op_sel_hi:[1,0]
    v_pk_add_f32 v[140:141], v[140:141], v[156:157]
    s_waitcnt vmcnt(2) lgkmcnt(0)
    v_mfma_f32_32x32x16_bf16 a[0:15], v[80:83], v[32:35], a[0:15]
    ds_read_b64_tr_b16 v[88:89], v238 offset:2048
    ds_read_b64_tr_b16 v[90:91], v238 offset:2560
    v_pk_add_f32 v[142:143], v[142:143], v[158:159]
    v_pk_add_f32 v[172:173], v[172:173], v[188:189]
    v_pk_add_f32 v[174:175], v[174:175], v[190:191]
    v_mfma_f32_32x32x16_bf16 a[16:31], v[84:87], v[32:35], a[16:31]
    ds_read_b64_tr_b16 v[92:93], v238 offset:3072
    ds_read_b64_tr_b16 v[94:95], v238 offset:3584
    v_pk_add_f32 v[140:141], v[140:141], v[172:173]
    v_pk_add_f32 v[142:143], v[142:143], v[174:175]
    v_pk_mul_f32 v[140:141], v[140:141], v[252:253] op_sel_hi:[1,0]
    v_mfma_f32_32x32x16_bf16 a[32:47], v[80:83], v[36:39], a[32:47]
    v_pk_mul_f32 v[142:143], v[142:143], v[252:253] op_sel_hi:[1,0]
    v_add_u32 v10, s43, v9
    v_mov_b32 v8, 1.0
    v_mfma_f32_32x32x16_bf16 a[48:63], v[84:87], v[36:39], a[48:63]
    s_xor_b32 s56, s36, 1
    s_mul_i32 s56, s56, 24576
    v_add_u32 v11, s56, v9
    s_waitcnt vmcnt(0) lgkmcnt(0)
    v_mfma_f32_32x32x16_bf16 a[0:15], v[88:91], v[40:43], a[0:15]
    s_xor_b32 s56, s36, 2
    s_mul_i32 s56, s56, 24576
    v_add_u32 v12, s56, v9
    v_mfma_f32_32x32x16_bf16 a[16:31], v[92:95], v[40:43], a[16:31]
    s_xor_b32 s56, s36, 3
    s_mul_i32 s56, s56, 24576
    v_add_u32 v13, s56, v9
    v_mfma_f32_32x32x16_bf16 a[32:47], v[88:91], v[44:47], a[32:47]
    v_mfma_f32_32x32x16_bf16 a[48:63], v[92:95], v[44:47], a[48:63]
    s_nop 1
    ds_write_b128 v10, a[16:19] offset:12288
    ds_write_b128 v10, a[20:23] offset:13312
    ds_write_b128 v10, a[24:27] offset:14336
    ds_write_b128 v10, a[28:31] offset:15360
    ds_write_b128 v10, a[32:35] offset:16384
    ds_write_b128 v10, a[36:39] offset:17408
    ds_write_b128 v10, a[40:43] offset:18432
    ds_write_b128 v10, a[44:47] offset:19456
    s_nop 3
    ds_write_b128 v10, a[48:51] offset:20480
    ds_write_b128 v10, a[52:55] offset:21504
    ds_write_b128 v10, a[56:59] offset:22528
    ds_write_b128 v10, a[60:63] offset:23552
    v_accvgpr_read_b32 v16, a0
    v_accvgpr_read_b32 v17, a1
    v_accvgpr_read_b32 v18, a2
    v_accvgpr_read_b32 v19, a3
    v_accvgpr_read_b32 v20, a4
    v_accvgpr_read_b32 v21, a5
    v_accvgpr_read_b32 v22, a6
    v_accvgpr_read_b32 v23, a7
    v_accvgpr_read_b32 v24, a8
    v_accvgpr_read_b32 v25, a9
    v_accvgpr_read_b32 v26, a10
    v_accvgpr_read_b32 v27, a11
    v_accvgpr_read_b32 v28, a12
    v_accvgpr_read_b32 v29, a13
    v_accvgpr_read_b32 v30, a14
    v_accvgpr_read_b32 v31, a15
    s_waitcnt lgkmcnt(0)
    s_barrier
    ds_read_b128 v[32:35], v11 offset:12288
    ds_read_b128 v[48:51], v12 offset:16384
    ds_read_b128 v[64:67], v13 offset:20480
    ds_read_b128 v[36:39], v11 offset:13312
    ds_read_b128 v[52:55], v12 offset:17408
    ds_read_b128 v[68:71], v13 offset:21504
    ds_read_b128 v[40:43], v11 offset:14336
    ds_read_b128 v[56:59], v12 offset:18432
    ds_read_b128 v[72:75], v13 offset:22528
    ds_read_b128 v[44:47], v11 offset:15360
    ds_read_b128 v[60:63], v12 offset:19456
    ds_read_b128 v[76:79], v13 offset:23552
    s_waitcnt lgkmcnt(9)
    v_pk_add_f32 v[16:17], v[16:17], v[32:33]
    v_pk_add_f32 v[18:19], v[18:19], v[34:35]
    v_pk_add_f32 v[48:49], v[48:49], v[64:65]
    v_pk_add_f32 v[50:51], v[50:51], v[66:67]
    v_pk_add_f32 v[16:17], v[16:17], v[48:49]
    v_pk_add_f32 v[18:19], v[18:19], v[50:51]
    v_pk_mul_f32 v[192:193], v[16:17], v[250:251] op_sel_hi:[1,0]
    v_pk_mul_f32 v[194:195], v[18:19], v[250:251] op_sel_hi:[1,0]
    v_exp_f32 v192, v192
    v_exp_f32 v193, v193
    v_exp_f32 v194, v194
    v_exp_f32 v195, v195
    v_pk_mul_f32 v[128:129], v[128:129], v[16:17]
    v_pk_mul_f32 v[130:131], v[130:131], v[18:19]
    v_pk_add_f32 v[192:193], v[192:193], v[8:9] op_sel_hi:[1,0]
    v_pk_add_f32 v[194:195], v[194:195], v[8:9] op_sel_hi:[1,0]
    v_rcp_f32 v192, v192
    v_rcp_f32 v193, v193
    v_rcp_f32 v194, v194
    v_rcp_f32 v195, v195
    s_nop 0
    v_pk_fma_f32 v[128:129], v[128:129], v[192:193], v[96:97]
    v_pk_fma_f32 v[130:131], v[130:131], v[194:195], v[98:99]
    v_cvt_pk_bf16_f32 v196, v128, v129
    v_cvt_pk_bf16_f32 v197, v130, v131
    buffer_store_dwordx2 v[196:197], v239, s[24:27], 0 offen offset:0
    s_waitcnt lgkmcnt(6)
    v_pk_add_f32 v[20:21], v[20:21], v[36:37]
    v_pk_add_f32 v[22:23], v[22:23], v[38:39]
    v_pk_add_f32 v[52:53], v[52:53], v[68:69]
    v_pk_add_f32 v[54:55], v[54:55], v[70:71]
    v_pk_add_f32 v[20:21], v[20:21], v[52:53]
    v_pk_add_f32 v[22:23], v[22:23], v[54:55]
    v_pk_mul_f32 v[200:201], v[20:21], v[250:251] op_sel_hi:[1,0]
    v_pk_mul_f32 v[202:203], v[22:23], v[250:251] op_sel_hi:[1,0]
    v_exp_f32 v200, v200
    v_exp_f32 v201, v201
    v_exp_f32 v202, v202
    v_exp_f32 v203, v203
    v_pk_mul_f32 v[132:133], v[132:133], v[20:21]
    v_pk_mul_f32 v[134:135], v[134:135], v[22:23]
    v_pk_add_f32 v[200:201], v[200:201], v[8:9] op_sel_hi:[1,0]
    v_pk_add_f32 v[202:203], v[202:203], v[8:9] op_sel_hi:[1,0]
    v_rcp_f32 v200, v200
    v_rcp_f32 v201, v201
    v_rcp_f32 v202, v202
    v_rcp_f32 v203, v203
    s_nop 0
    v_pk_fma_f32 v[132:133], v[132:133], v[200:201], v[100:101]
    v_pk_fma_f32 v[134:135], v[134:135], v[202:203], v[102:103]
    v_cvt_pk_bf16_f32 v204, v132, v133
    v_cvt_pk_bf16_f32 v205, v134, v135
    buffer_store_dwordx2 v[204:205], v239, s[24:27], 0 offen offset:16
    s_waitcnt lgkmcnt(3)
    v_pk_add_f32 v[24:25], v[24:25], v[40:41]
    v_pk_add_f32 v[26:27], v[26:27], v[42:43]
    v_pk_add_f32 v[56:57], v[56:57], v[72:73]
    v_pk_add_f32 v[58:59], v[58:59], v[74:75]
    v_pk_add_f32 v[24:25], v[24:25], v[56:57]
    v_pk_add_f32 v[26:27], v[26:27], v[58:59]
    v_pk_mul_f32 v[192:193], v[24:25], v[250:251] op_sel_hi:[1,0]
    v_pk_mul_f32 v[194:195], v[26:27], v[250:251] op_sel_hi:[1,0]
    v_exp_f32 v192, v192
    v_exp_f32 v193, v193
    v_exp_f32 v194, v194
    v_exp_f32 v195, v195
    v_pk_mul_f32 v[136:137], v[136:137], v[24:25]
    v_pk_mul_f32 v[138:139], v[138:139], v[26:27]
    v_pk_add_f32 v[192:193], v[192:193], v[8:9] op_sel_hi:[1,0]
    v_pk_add_f32 v[194:195], v[194:195], v[8:9] op_sel_hi:[1,0]
    v_rcp_f32 v192, v192
    v_rcp_f32 v193, v193
    v_rcp_f32 v194, v194
    v_rcp_f32 v195, v195
    s_nop 0
    v_pk_fma_f32 v[136:137], v[136:137], v[192:193], v[104:105]
    v_pk_fma_f32 v[138:139], v[138:139], v[194:195], v[106:107]
    v_cvt_pk_bf16_f32 v196, v136, v137
    v_cvt_pk_bf16_f32 v197, v138, v139
    buffer_store_dwordx2 v[196:197], v239, s[24:27], 0 offen offset:32
    s_waitcnt lgkmcnt(0)
    v_pk_add_f32 v[28:29], v[28:29], v[44:45]
    v_pk_add_f32 v[30:31], v[30:31], v[46:47]
    v_pk_add_f32 v[60:61], v[60:61], v[76:77]
    v_pk_add_f32 v[62:63], v[62:63], v[78:79]
    v_pk_add_f32 v[28:29], v[28:29], v[60:61]
    v_pk_add_f32 v[30:31], v[30:31], v[62:63]
    v_pk_mul_f32 v[200:201], v[28:29], v[250:251] op_sel_hi:[1,0]
    v_pk_mul_f32 v[202:203], v[30:31], v[250:251] op_sel_hi:[1,0]
    v_exp_f32 v200, v200
    v_exp_f32 v201, v201
    v_exp_f32 v202, v202
    v_exp_f32 v203, v203
    v_pk_mul_f32 v[140:141], v[140:141], v[28:29]
    v_pk_mul_f32 v[142:143], v[142:143], v[30:31]
    v_pk_add_f32 v[200:201], v[200:201], v[8:9] op_sel_hi:[1,0]
    v_pk_add_f32 v[202:203], v[202:203], v[8:9] op_sel_hi:[1,0]
    v_rcp_f32 v200, v200
    v_rcp_f32 v201, v201
    v_rcp_f32 v202, v202
    v_rcp_f32 v203, v203
    s_nop 0
    v_pk_fma_f32 v[140:141], v[140:141], v[200:201], v[108:109]
    v_pk_fma_f32 v[142:143], v[142:143], v[202:203], v[110:111]
    v_cvt_pk_bf16_f32 v204, v140, v141
    v_cvt_pk_bf16_f32 v205, v142, v143
    buffer_store_dwordx2 v[204:205], v239, s[24:27], 0 offen offset:48
L_end:
    s_endpgm
.section .rodata,"a"
.p2align 6
.amdhsa_kernel recurrent_scan__linear_attn_block__dense_activation_relu__prompt_kernel
  .amdhsa_next_free_vgpr 512
  .amdhsa_next_free_sgpr 102
  .amdhsa_accum_offset 256
  .amdhsa_group_segment_fixed_size 0
  .amdhsa_kernarg_size 72
  .amdhsa_user_sgpr_count 2
  .amdhsa_user_sgpr_kernarg_segment_ptr 1
  .amdhsa_system_sgpr_workgroup_id_x 1
.end_amdhsa_kernel
```
